```python
import torch

def _softmax(x, axis=-1):
    return torch.softmax(x, dim=axis)
def _gelu(x):
    return torch.nn.functional.gelu(x, approximate="tanh")
def _silu(x):
    return torch.nn.functional.silu(x)
def _sigmoid(x):
    return torch.sigmoid(x)
def _layernorm(x, axis=-1, eps=1e-5):
    m = x.mean(dim=axis, keepdim=True)
    v = x.var(dim=axis, keepdim=True, unbiased=False)
    return (x - m) / torch.sqrt(v + eps)
def _scatter_add(tgt, idx, src, axis=0):
    return tgt.clone().index_add_(axis, idx, src)
def _segment_sum(src, seg, n):
    out = torch.zeros((n,) + src.shape[1:], dtype=src.dtype)
    return out.index_add_(0, seg, src)
def _pad(x, pw):
    flat = tuple(v for pair in reversed(pw) for v in pair)
    return torch.nn.functional.pad(x, flat)

kernel_name = 'concat_heads__sliding_local_dilated__sliding_block__prompt'

def setup_inputs():

    _w = (lambda a: (lambda t: t.to(torch.bfloat16) if t.is_floating_point() else t)(torch.as_tensor(a)))
    def _A_setup():
        B, S, D = 1, 2048, 512
        return {
            "x": _w((lambda *s: torch.randn(*s, dtype=torch.bfloat16) * 0.2)(B, S, D)),
            "wqkv": _w((lambda *s: torch.randn(*s, dtype=torch.bfloat16) * 0.2)(D, 3 * D)),
            "wo": _w((lambda *s: torch.randn(*s, dtype=torch.bfloat16) * 0.05)(D, D)),
        }
    _A_in = _A_setup()

    def _B_setup():
        B, S, D = 1, 2048, 512
        return {
            "x": _w((lambda *s: torch.randn(*s, dtype=torch.bfloat16) * 0.2)(B, S, D)),
            "wqkv": _w((lambda *s: torch.randn(*s, dtype=torch.bfloat16) * 0.2)(D, 3 * D)),
            "wo": _w((lambda *s: torch.randn(*s, dtype=torch.bfloat16) * 0.05)(D, D)),
        }
    _B_in = _B_setup()

    return {
        "A_x": _A_in["x"],
        "A_wqkv": _A_in["wqkv"],
        "A_wo": _A_in["wo"],
        "B_x": _B_in["x"],
        "B_wqkv": _B_in["wqkv"],
        "B_wo": _B_in["wo"],
    }

def reference(A_x, A_wqkv, A_wo, B_x, B_wqkv, B_wo):
    def _A_ref(x, wqkv, wo):
        B, S, D = x.shape
        H = 32; Dh = D // H
        W, dil = 8, 2
        qkv = (lambda x, *d: x.permute(*d))((x @ wqkv).reshape(B, S, 3, H, Dh), 2, 0, 3, 1, 4)
        q, k, v = qkv[0], qkv[1], qkv[2]
        scale = Dh ** -0.5
        pos = torch.arange(S)
        off = torch.arange(W) * dil
        idx = pos[:, None] - off[None, :]
        mask = idx >= 0
        idx_c = torch.where(mask, idx, 0).reshape(-1)
        kg = k[:, :, idx_c, :].reshape(B, H, S, W, Dh)
        vg = v[:, :, idx_c, :].reshape(B, H, S, W, Dh)
        logits = torch.einsum("bhsd,bhswd->bhsw", q, kg) * scale
        logits = torch.where(mask[None, None, :, :], logits, -1e9)
        attn = _softmax(logits, axis=-1)
        o = torch.einsum("bhsw,bhswd->bhsd", attn, vg)
        return (lambda x, *d: x.permute(*d))(o, 0, 2, 1, 3).reshape(B, S, D) @ wo

    def _B_ref(x, wqkv, wo):
        B, S, D = x.shape
        H = 32; Dh = D // H; W = 256
        qkv = (lambda x, *d: x.permute(*d))((x @ wqkv).reshape(B, S, 3, H, Dh), 2, 0, 3, 1, 4)
        q, k, v = qkv[0], qkv[1], qkv[2]
        scores = torch.einsum("bhqd,bhkd->bhqk", q, k) * (Dh ** -0.5)
        idx = torch.arange(S)
        mask = (idx[:, None] - idx[None, :] >= 0) & (idx[:, None] - idx[None, :] < W)
        scores = torch.where(mask[None, None], scores, -1e9)
        p = _softmax(scores, axis=-1)
        o = torch.einsum("bhqk,bhkd->bhqd", p, v)
        return (lambda x, *d: x.permute(*d))(o, 0, 2, 1, 3).reshape(B, S, D) @ wo

    a = _A_ref(A_x, A_wqkv, A_wo)
    b = _B_ref(B_x, B_wqkv, B_wo)
    return torch.concatenate([a, b], axis=-1)
```

```asm
; @launch grid=(256,1,1) block=(512,1,1) lds=163840
.amdgcn_target "amdgcn-amd-amdhsa--gfx950"
.text
.globl concat_heads__sliding_local_dilated__sliding_block__prompt_kernel
.p2align 12
.p2align 8
.type concat_heads__sliding_local_dilated__sliding_block__prompt_kernel,@function
concat_heads__sliding_local_dilated__sliding_block__prompt_kernel:
    s_cmp_ge_u32 s2, 256
    s_cbranch_scc1 L_end
    s_load_dwordx16 s[32:47], s[0:1], 0
    s_load_dwordx2 s[24:25], s[0:1], 64
    s_getpc_b64 s[62:63]
    s_lshr_b32 s50, s2, 3
    s_mul_i32 s50, s50, 5
    v_add_u32 v13, s50, v0
    v_lshlrev_b32 v13, 7, v13
    v_cmp_gt_u32 vcc, 5, v0
    s_and_saveexec_b64 s[60:61], vcc
    s_cbranch_execz L_noct
    global_load_dword v254, v13, s[62:63]
L_noct:
    s_mov_b64 exec, -1
    v_lshrrev_b32 v13, 6, v0
    v_and_b32 v1, 63, v0
    v_readfirstlane_b32 s6, v13
    s_and_b32 s55, s2, 7
    s_lshr_b32 s54, s2, 3
    s_bfe_u32 s50, s2, 0x10002
    s_lshl_b32 s50, s50, 1
    s_xor_b32 s55, s55, s50
    s_lshr_b32 s50, s55, 1
    s_lshl_b32 s50, s50, 2
    s_bfe_u32 s51, s54, 0x20002
    s_add_u32 s4, s50, s51
    s_and_b32 s50, s55, 1
    s_lshl_b32 s50, s50, 2
    s_and_b32 s52, s54, 3
    s_add_u32 s5, s50, s52
    s_add_u32 s53, s51, s52
    s_lshl_b32 s53, s53, 1
    s_lshl_b32 s7, s6, 10
    v_lshrrev_b32 v13, 4, v1
    s_and_b32 s50, s6, 1
    s_lshl_b32 s50, s50, 2
    v_add_u32 v13, s50, v13
    v_and_b32 v14, 7, v1
    v_xor_b32 v13, v13, v14
    v_lshlrev_b32 v13, 4, v13
    v_lshrrev_b32 v14, 3, v1
    v_lshl_add_u32 v2, v14, 10, v13
    s_lshl_b32 s50, s6, 13
    v_add_u32 v2, s50, v2
    v_add_u32 v3, 0x10000, v2
    v_bfe_u32 v13, v1, 2, 3
    s_lshl_b32 s50, s6, 3
    v_add_u32 v13, s50, v13
    v_lshrrev_b32 v14, 5, v1
    v_lshlrev_b32 v14, 6, v14
    v_and_b32 v15, 3, v1
    v_lshl_add_u32 v14, v15, 4, v14
    s_and_b32 s50, s6, 1
    s_lshl_b32 s50, s50, 5
    v_xor_b32 v14, s50, v14
    v_mul_u32_u24 v4, 3072, v13
    v_add_u32 v4, v4, v14
    v_add_u32 v4, 0x400, v4
    s_mov_b32 s10, 2097152
    s_mov_b32 s11, 0x20000
    s_mov_b32 s14, 1572864
    s_mov_b32 s15, 0x20000
    s_mov_b32 s23, 0x20000
    s_lshl_b32 s50, s4, 17
    s_lshl_b32 s51, s5, 7
    s_cmp_lt_u32 s2, 128
    s_cselect_b32 s3, 1, 0
    s_cselect_b32 s53, 0, s53
    s_waitcnt lgkmcnt(0)
    s_cselect_b64 s[8:9], s[38:39], s[32:33]
    s_cselect_b64 s[12:13], s[40:41], s[34:35]
    s_cselect_b64 s[16:17], s[42:43], s[36:37]
    s_cselect_b64 s[70:71], s[36:37], s[42:43]
    s_mov_b64 s[28:29], s[46:47]
    s_cbranch_scc1 L_notouch
    v_lshrrev_b32 v13, 1, v1
    v_lshlrev_b32 v13, 10, v13
    v_and_b32 v14, 1, v1
    v_lshl_add_u32 v13, v14, 7, v13
    v_lshrrev_b32 v14, 4, v1
    v_bfe_u32 v15, v1, 2, 2
    v_lshl_add_u32 v14, v14, 6, v15
    v_mul_u32_u24 v14, 3072, v14
    v_and_b32 v15, 3, v1
    v_lshl_add_u32 v14, v15, 7, v14
    s_and_b32 s64, s5, 3
    s_lshl_b32 s64, s64, 15
    s_add_u32 s64, s64, s50
    s_and_b32 s65, s54, 15
    s_mul_i32 s65, s65, 12288
    s_and_b32 s52, s51, 512
    s_add_u32 s65, s65, s52
    s_lshl_b32 s52, s6, 2
    s_lshr_b32 s52, 0xb53a9428, s52
    s_bitcmp1_b32 s52, 3
    s_cbranch_scc1 L_t0x
    s_bitcmp1_b32 0xff, s6
    s_cselect_b64 s[20:21], s[40:41], s[34:35]
    s_mov_b32 s22, 1572864
    s_and_b32 s58, s52, 1
    s_mul_i32 s58, s58, 786432
    s_add_u32 s58, s58, s65
    s_and_b32 s52, s52, 6
    s_lshl_b32 s52, s52, 9
    s_add_u32 s58, s58, s52
    buffer_load_dword v250, v14, s[20:23], s58 offen
    s_branch L_t0d
L_t0x:
    s_bitcmp1_b32 0xff, s6
    s_cselect_b64 s[20:21], s[38:39], s[32:33]
    s_mov_b32 s22, 2097152
    s_and_b32 s52, s52, 3
    s_lshl_b32 s52, s52, 8
    s_add_u32 s58, s52, s64
    buffer_load_dword v250, v13, s[20:23], s58 offen
L_t0d:
    s_barrier
    s_lshl_b32 s52, s6, 2
    s_lshr_b32 s52, 0x10543210, s52
    s_bitcmp1_b32 s52, 3
    s_cbranch_scc1 L_t1x
    s_bitcmp1_b32 0x3, s6
    s_cselect_b64 s[20:21], s[40:41], s[34:35]
    s_mov_b32 s22, 1572864
    s_and_b32 s58, s52, 1
    s_mul_i32 s58, s58, 786432
    s_add_u32 s58, s58, s65
    s_and_b32 s52, s52, 6
    s_lshl_b32 s52, s52, 9
    s_add_u32 s58, s58, s52
    buffer_load_dword v251, v14, s[20:23], s58 offen
    s_branch L_t1d
L_t1x:
    s_bitcmp1_b32 0x3, s6
    s_cselect_b64 s[20:21], s[38:39], s[32:33]
    s_mov_b32 s22, 2097152
    s_and_b32 s52, s52, 3
    s_lshl_b32 s52, s52, 8
    s_add_u32 s58, s52, s64
    buffer_load_dword v251, v13, s[20:23], s58 offen
L_t1d:
    s_barrier
L_notouch:
    s_mov_b64 s[20:21], s[44:45]
    s_add_u32 s52, s53, 0
    s_and_b32 s52, s52, 7
    s_lshl_b32 s32, s52, 7
    s_add_u32 s32, s32, s50
    s_mul_i32 s40, s52, 196608
    s_add_u32 s40, s40, s51
    s_add_u32 m0, s7, 0
    s_nop 0
    buffer_load_dwordx4 v2, s[8:11], s32 offen lds
    s_add_u32 m0, s7, 65536
    s_nop 0
    buffer_load_dwordx4 v4, s[12:15], s40 offen lds
    s_add_u32 m0, s7, 8192
    s_nop 0
    buffer_load_dwordx4 v3, s[8:11], s32 offen lds
    s_add_u32 m0, s7, 72704
    s_nop 0
    buffer_load_dwordx4 v4, s[12:15], s40 offen offset:1024 lds
    s_mov_b32 s30, 256
    s_mov_b32 s31, 0x20000
    s_xor_b32 s52, s6, 7
    s_or_b32 s52, s2, s52
    s_cmp_eq_u32 s52, 0
    s_cbranch_scc1 L_c_1
L_c_1r:
    s_add_u32 s52, s53, 1
    s_and_b32 s52, s52, 7
    s_lshl_b32 s33, s52, 7
    s_add_u32 s33, s33, s50
    s_mul_i32 s41, s52, 196608
    s_add_u32 s41, s41, s51
    s_add_u32 s52, s53, 2
    s_and_b32 s52, s52, 7
    s_lshl_b32 s34, s52, 7
    s_add_u32 s34, s34, s50
    s_mul_i32 s42, s52, 196608
    s_add_u32 s42, s42, s51
    s_add_u32 s52, s53, 3
    s_and_b32 s52, s52, 7
    s_lshl_b32 s35, s52, 7
    s_add_u32 s35, s35, s50
    s_mul_i32 s43, s52, 196608
    s_add_u32 s43, s43, s51
    s_add_u32 s52, s53, 4
    s_and_b32 s52, s52, 7
    s_lshl_b32 s36, s52, 7
    s_add_u32 s36, s36, s50
    s_mul_i32 s44, s52, 196608
    s_add_u32 s44, s44, s51
    s_add_u32 s52, s53, 5
    s_and_b32 s52, s52, 7
    s_lshl_b32 s37, s52, 7
    s_add_u32 s37, s37, s50
    s_mul_i32 s45, s52, 196608
    s_add_u32 s45, s45, s51
    s_add_u32 s52, s53, 6
    s_and_b32 s52, s52, 7
    s_lshl_b32 s38, s52, 7
    s_add_u32 s38, s38, s50
    s_mul_i32 s46, s52, 196608
    s_add_u32 s46, s46, s51
    s_add_u32 s52, s53, 7
    s_and_b32 s52, s52, 7
    s_lshl_b32 s39, s52, 7
    s_add_u32 s39, s39, s50
    s_mul_i32 s47, s52, 196608
    s_add_u32 s47, s47, s51
    s_mov_b32 s18, 524288
    s_mov_b32 s19, 0x20000
    s_mov_b32 s22, 4194304
    s_mov_b32 s26, 14680064
    s_mov_b32 s27, 0x20000
    s_lshr_b32 s57, s6, 2
    s_mul_i32 s56, s57, 3
    s_and_b32 s50, s6, 3
    s_xor_b32 s56, s56, s50
    s_lshl_b32 s59, s4, 2
    s_add_u32 s59, s59, s56
    v_and_b32 v13, 15, v1
    v_lshrrev_b32 v14, 4, v1
    v_bfe_u32 v15, v1, 1, 3
    v_xor_b32 v15, v15, v14
    v_lshlrev_b32 v15, 4, v15
    v_lshl_add_u32 v8, v13, 7, v15
    s_lshl_b32 s50, s56, 12
    v_add_u32 v8, s50, v8
    v_xor_b32 v9, 64, v8
    v_bfe_u32 v15, v1, 2, 2
    v_lshlrev_b32 v5, 6, v15
    v_bfe_u32 v15, v1, 4, 1
    v_lshl_add_u32 v5, v15, 5, v5
    v_and_b32 v15, 3, v1
    v_lshl_add_u32 v5, v15, 3, v5
    v_lshl_add_u32 v5, v14, 10, v5
    s_lshl_b32 s50, s57, 9
    v_add_u32 v5, s50, v5
    v_add_u32 v6, 0x10000, v5
    v_xor_b32 v7, 32, v6
    v_lshlrev_b32 v12, 4, v1
    s_lshl_b32 s50, s56, 13
    s_lshl_b32 s51, s57, 11
    s_add_u32 s50, s50, s51
    s_add_u32 s50, s50, 131072
    v_add_u32 v0, s50, v12
    s_lshl_b32 s50, s3, 3
    s_add_u32 s50, s50, s5
    s_lshl_b32 s50, s50, 6
    s_add_u32 s50, s50, s59
    s_lshl_b32 s1, s50, 13
    s_add_u32 s1, s1, s51
    s_lshl_b32 s0, s50, 8
    s_lshl_b32 s51, s57, 7
    s_add_u32 s0, s0, s51
    s_add_u32 s0, s0, 12582912
    s_sub_u32 s50, s50, s56
    s_add_u32 s50, s50, s6
    s_sub_u32 s50, s50, 8
    s_lshl_b32 s51, s4, 2
    s_add_u32 s51, s51, s6
    s_cmp_lt_u32 s51, 8
    s_cselect_b32 s66, 1, 0
    s_cselect_b32 s50, 0, s50
    s_lshl_b32 s64, s50, 13
    s_lshl_b32 s65, s50, 8
    s_add_u32 s65, s65, 12582912
    s_and_b32 s50, s0, 0xffffff00
    s_sub_u32 s50, s50, 256
    s_cmp_eq_u32 s3, 0
    s_cselect_b32 s66, s56, s66
    s_cselect_b32 s65, s50, s65
    s_lshl_b32 s50, s3, 6
    s_add_u32 s50, s50, s59
    s_lshl_b32 s51, s50, 4
    s_lshl_b32 s52, s5, 1
    s_add_u32 s51, s51, s52
    s_add_u32 s51, s51, s57
    s_lshl_b32 s68, s51, 11
    s_add_u32 s68, s68, 8388608
    s_lshl_b32 s69, s51, 8
    s_add_u32 s69, s69, 13107200
    s_mov_b32 s60, 0xffff
    s_mov_b32 s61, 0xffff
    s_lshl_b32 s50, s55, 1
    s_bfe_u32 s51, s54, 0x10003
    s_add_u32 s50, s50, s51
    s_lshl_b32 s50, s50, 2
    s_and_b32 s51, s6, 3
    s_add_u32 s55, s50, s51
    s_cmp_eq_u32 s3, 0
    s_cbranch_scc1 L_maskA
    v_and_b32 v13, 31, v1
    v_lshrrev_b32 v14, 5, v1
    v_lshlrev_b32 v14, 2, v14
    v_sub_u32 v13, v13, v14
    s_mov_b32 s50, 0xff800000
    v_subrev_u32 v14, 0, v13
    v_and_b32 v40, s50, v14
    v_xor_b32 v56, s50, v40
    v_subrev_u32 v14, 1, v13
    v_and_b32 v41, s50, v14
    v_xor_b32 v57, s50, v41
    v_subrev_u32 v14, 2, v13
    v_and_b32 v42, s50, v14
    v_xor_b32 v58, s50, v42
    v_subrev_u32 v14, 3, v13
    v_and_b32 v43, s50, v14
    v_xor_b32 v59, s50, v43
    v_subrev_u32 v14, 8, v13
    v_and_b32 v44, s50, v14
    v_xor_b32 v60, s50, v44
    v_subrev_u32 v14, 9, v13
    v_and_b32 v45, s50, v14
    v_xor_b32 v61, s50, v45
    v_subrev_u32 v14, 10, v13
    v_and_b32 v46, s50, v14
    v_xor_b32 v62, s50, v46
    v_subrev_u32 v14, 11, v13
    v_and_b32 v47, s50, v14
    v_xor_b32 v63, s50, v47
    v_subrev_u32 v14, 16, v13
    v_and_b32 v48, s50, v14
    v_xor_b32 v64, s50, v48
    v_subrev_u32 v14, 17, v13
    v_and_b32 v49, s50, v14
    v_xor_b32 v65, s50, v49
    v_subrev_u32 v14, 18, v13
    v_and_b32 v50, s50, v14
    v_xor_b32 v66, s50, v50
    v_subrev_u32 v14, 19, v13
    v_and_b32 v51, s50, v14
    v_xor_b32 v67, s50, v51
    v_subrev_u32 v14, 24, v13
    v_and_b32 v52, s50, v14
    v_xor_b32 v68, s50, v52
    v_subrev_u32 v14, 25, v13
    v_and_b32 v53, s50, v14
    v_xor_b32 v69, s50, v53
    v_subrev_u32 v14, 26, v13
    v_and_b32 v54, s50, v14
    v_xor_b32 v70, s50, v54
    v_subrev_u32 v14, 27, v13
    v_and_b32 v55, s50, v14
    v_xor_b32 v71, s50, v55
    s_branch L_maskdone
L_c_1:
    s_memrealtime s[48:49]
    s_waitcnt lgkmcnt(0)
    s_or_b32 s49, s49, 0x80000000
    v_mov_b32 v24, s48
    v_mov_b32 v25, s49
    s_mov_b64 exec, 1
    buffer_store_dwordx2 v[24:25], off, s[28:31], 0 sc1
    s_mov_b64 exec, -1
    s_branch L_c_1r
L_maskA:
    v_and_b32 v13, 31, v1
    v_lshrrev_b32 v14, 5, v1
    v_lshlrev_b32 v14, 2, v14
    v_sub_u32 v13, v13, v14
    s_mov_b32 s50, 0xf149f2ca
    v_subrev_u32 v14, 0, v13
    v_and_b32 v14, -15, v14
    v_cvt_f32_u32 v14, v14
    v_mul_f32 v40, s50, v14
    v_mov_b32 v56, s50
    v_subrev_u32 v14, 1, v13
    v_and_b32 v14, -15, v14
    v_cvt_f32_u32 v14, v14
    v_mul_f32 v41, s50, v14
    v_mov_b32 v57, s50
    v_subrev_u32 v14, 2, v13
    v_and_b32 v14, -15, v14
    v_cvt_f32_u32 v14, v14
    v_mul_f32 v42, s50, v14
    v_mov_b32 v58, s50
    v_subrev_u32 v14, 3, v13
    v_and_b32 v14, -15, v14
    v_cvt_f32_u32 v14, v14
    v_mul_f32 v43, s50, v14
    v_mov_b32 v59, s50
    v_subrev_u32 v14, 8, v13
    v_and_b32 v14, -15, v14
    v_cvt_f32_u32 v14, v14
    v_mul_f32 v44, s50, v14
    v_mov_b32 v60, s50
    v_subrev_u32 v14, 9, v13
    v_and_b32 v14, -15, v14
    v_cvt_f32_u32 v14, v14
    v_mul_f32 v45, s50, v14
    v_mov_b32 v61, s50
    v_subrev_u32 v14, 10, v13
    v_and_b32 v14, -15, v14
    v_cvt_f32_u32 v14, v14
    v_mul_f32 v46, s50, v14
    v_mov_b32 v62, s50
    v_subrev_u32 v14, 11, v13
    v_and_b32 v14, -15, v14
    v_cvt_f32_u32 v14, v14
    v_mul_f32 v47, s50, v14
    v_mov_b32 v63, s50
    v_subrev_u32 v14, 16, v13
    v_and_b32 v14, -15, v14
    v_cvt_f32_u32 v14, v14
    v_mul_f32 v48, s50, v14
    v_add_u32 v14, 16, v13
    v_and_b32 v14, -15, v14
    v_cvt_f32_u32 v14, v14
    v_mul_f32 v64, s50, v14
    v_subrev_u32 v14, 17, v13
    v_and_b32 v14, -15, v14
    v_cvt_f32_u32 v14, v14
    v_mul_f32 v49, s50, v14
    v_add_u32 v14, 15, v13
    v_and_b32 v14, -15, v14
    v_cvt_f32_u32 v14, v14
    v_mul_f32 v65, s50, v14
    v_subrev_u32 v14, 18, v13
    v_and_b32 v14, -15, v14
    v_cvt_f32_u32 v14, v14
    v_mul_f32 v50, s50, v14
    v_add_u32 v14, 14, v13
    v_and_b32 v14, -15, v14
    v_cvt_f32_u32 v14, v14
    v_mul_f32 v66, s50, v14
    v_subrev_u32 v14, 19, v13
    v_and_b32 v14, -15, v14
    v_cvt_f32_u32 v14, v14
    v_mul_f32 v51, s50, v14
    v_add_u32 v14, 13, v13
    v_and_b32 v14, -15, v14
    v_cvt_f32_u32 v14, v14
    v_mul_f32 v67, s50, v14
    v_subrev_u32 v14, 24, v13
    v_and_b32 v14, -15, v14
    v_cvt_f32_u32 v14, v14
    v_mul_f32 v52, s50, v14
    v_add_u32 v14, 8, v13
    v_and_b32 v14, -15, v14
    v_cvt_f32_u32 v14, v14
    v_mul_f32 v68, s50, v14
    v_subrev_u32 v14, 25, v13
    v_and_b32 v14, -15, v14
    v_cvt_f32_u32 v14, v14
    v_mul_f32 v53, s50, v14
    v_add_u32 v14, 7, v13
    v_and_b32 v14, -15, v14
    v_cvt_f32_u32 v14, v14
    v_mul_f32 v69, s50, v14
    v_subrev_u32 v14, 26, v13
    v_and_b32 v14, -15, v14
    v_cvt_f32_u32 v14, v14
    v_mul_f32 v54, s50, v14
    v_add_u32 v14, 6, v13
    v_and_b32 v14, -15, v14
    v_cvt_f32_u32 v14, v14
    v_mul_f32 v70, s50, v14
    v_subrev_u32 v14, 27, v13
    v_and_b32 v14, -15, v14
    v_cvt_f32_u32 v14, v14
    v_mul_f32 v55, s50, v14
    v_add_u32 v14, 5, v13
    v_and_b32 v14, -15, v14
    v_cvt_f32_u32 v14, v14
    v_mul_f32 v71, s50, v14
L_maskdone:
    v_lshlrev_b32 v13, 3, v1
    v_and_b32 v10, 1, v1
    v_lshlrev_b32 v10, 7, v10
    v_and_b32 v11, 2, v1
    v_lshl_add_u32 v10, v11, 17, v10
    v_mov_b32 v11, 0
    s_mov_b32 exec_lo, 0x110000
    s_mov_b32 exec_hi, 0x110000
    v_mov_b32 v11, 0x3f803f80
    s_mov_b64 exec, -1
    s_add_u32 m0, s7, 16384
    s_nop 0
    buffer_load_dwordx4 v2, s[8:11], s33 offen lds
    s_add_u32 m0, s7, 81920
    s_nop 0
    buffer_load_dwordx4 v4, s[12:15], s41 offen lds
    s_add_u32 m0, s7, 24576
    s_nop 0
    buffer_load_dwordx4 v3, s[8:11], s33 offen lds
    s_add_u32 m0, s7, 89088
    s_nop 0
    buffer_load_dwordx4 v4, s[12:15], s41 offen offset:1024 lds
    s_waitcnt vmcnt(4)
    s_barrier
    ds_read_b128 v[128:131], v8 offset:0
    ds_read_b64_tr_b16 v[104:105], v6 offset:0
    ds_read_b64_tr_b16 v[106:107], v6 offset:256
    ds_read_b128 v[132:135], v8 offset:2048
    ds_read_b64_tr_b16 v[108:109], v7 offset:0
    ds_read_b64_tr_b16 v[110:111], v7 offset:256
    ds_read_b64_tr_b16 v[112:113], v6 offset:8192
    ds_read_b64_tr_b16 v[114:115], v6 offset:8448
    ds_read_b64_tr_b16 v[116:117], v7 offset:8192
    ds_read_b64_tr_b16 v[118:119], v7 offset:8448
    s_add_u32 m0, s7, 32768
    s_nop 0
    buffer_load_dwordx4 v2, s[8:11], s34 offen lds
    s_waitcnt lgkmcnt(4)
    v_mfma_f32_16x16x32_bf16 v[72:75], v[104:107], v[128:131], 0
    ds_read_b128 v[136:139], v9 offset:0
    ds_read_b64_tr_b16 v[120:121], v6 offset:4096
    v_mfma_f32_16x16x32_bf16 v[76:79], v[104:107], v[132:135], 0
    s_add_u32 m0, s7, 98304
    ds_read_b64_tr_b16 v[122:123], v6 offset:4352
    buffer_load_dwordx4 v4, s[12:15], s42 offen lds
    v_mfma_f32_16x16x32_bf16 v[80:83], v[108:111], v[128:131], 0
    ds_read_b128 v[140:143], v9 offset:2048
    ds_read_b64_tr_b16 v[124:125], v7 offset:4096
    v_mfma_f32_16x16x32_bf16 v[84:87], v[108:111], v[132:135], 0
    s_add_u32 m0, s7, 40960
    ds_read_b64_tr_b16 v[126:127], v7 offset:4352
    buffer_load_dwordx4 v3, s[8:11], s34 offen lds
    s_waitcnt lgkmcnt(6)
    v_mfma_f32_16x16x32_bf16 v[88:91], v[128:131], v[112:115], 0
    ds_read_b64_tr_b16 v[16:17], v6 offset:12288
    v_mfma_f32_16x16x32_bf16 v[96:99], v[132:135], v[112:115], 0
    s_add_u32 m0, s7, 105472
    ds_read_b64_tr_b16 v[18:19], v6 offset:12544
    buffer_load_dwordx4 v4, s[12:15], s42 offen offset:1024 lds
    v_mfma_f32_16x16x32_bf16 v[92:95], v[128:131], v[116:119], 0
    ds_read_b64_tr_b16 v[20:21], v7 offset:12288
    v_mfma_f32_16x16x32_bf16 v[100:103], v[132:135], v[116:119], 0
    ds_read_b64_tr_b16 v[22:23], v7 offset:12544
    s_waitcnt vmcnt(4)
    s_barrier
    s_waitcnt lgkmcnt(4)
    v_mfma_f32_16x16x32_bf16 v[72:75], v[120:123], v[136:139], v[72:75]
    ds_read_b128 v[144:147], v8 offset:16384
    ds_read_b64_tr_b16 v[104:105], v6 offset:16384
    v_mfma_f32_16x16x32_bf16 v[76:79], v[120:123], v[140:143], v[76:79]
    s_add_u32 m0, s7, 49152
    ds_read_b64_tr_b16 v[106:107], v6 offset:16640
    buffer_load_dwordx4 v2, s[8:11], s35 offen lds
    v_mfma_f32_16x16x32_bf16 v[80:83], v[124:127], v[136:139], v[80:83]
    ds_read_b128 v[148:151], v8 offset:18432
    ds_read_b64_tr_b16 v[108:109], v7 offset:16384
    v_mfma_f32_16x16x32_bf16 v[84:87], v[124:127], v[140:143], v[84:87]
    ds_read_b64_tr_b16 v[110:111], v7 offset:16640
    s_waitcnt lgkmcnt(6)
    v_mfma_f32_16x16x32_bf16 v[88:91], v[136:139], v[16:19], v[88:91]
    ds_read_b64_tr_b16 v[112:113], v6 offset:24576
    v_mfma_f32_16x16x32_bf16 v[96:99], v[140:143], v[16:19], v[96:99]
    s_add_u32 m0, s7, 114688
    ds_read_b64_tr_b16 v[114:115], v6 offset:24832
    buffer_load_dwordx4 v4, s[12:15], s43 offen lds
    v_mfma_f32_16x16x32_bf16 v[92:95], v[136:139], v[20:23], v[92:95]
    ds_read_b64_tr_b16 v[116:117], v7 offset:24576
    v_mfma_f32_16x16x32_bf16 v[100:103], v[140:143], v[20:23], v[100:103]
    ds_read_b64_tr_b16 v[118:119], v7 offset:24832
    s_waitcnt lgkmcnt(4)
    v_mfma_f32_16x16x32_bf16 v[72:75], v[104:107], v[144:147], v[72:75]
    ds_read_b128 v[152:155], v9 offset:16384
    ds_read_b64_tr_b16 v[120:121], v6 offset:20480
    v_mfma_f32_16x16x32_bf16 v[76:79], v[104:107], v[148:151], v[76:79]
    s_add_u32 m0, s7, 57344
    ds_read_b64_tr_b16 v[122:123], v6 offset:20736
    buffer_load_dwordx4 v3, s[8:11], s35 offen lds
    v_mfma_f32_16x16x32_bf16 v[80:83], v[108:111], v[144:147], v[80:83]
    ds_read_b128 v[156:159], v9 offset:18432
    ds_read_b64_tr_b16 v[124:125], v7 offset:20480
    v_mfma_f32_16x16x32_bf16 v[84:87], v[108:111], v[148:151], v[84:87]
    ds_read_b64_tr_b16 v[126:127], v7 offset:20736
    s_waitcnt lgkmcnt(6)
    v_mfma_f32_16x16x32_bf16 v[88:91], v[144:147], v[112:115], v[88:91]
    ds_read_b64_tr_b16 v[16:17], v6 offset:28672
    v_mfma_f32_16x16x32_bf16 v[96:99], v[148:151], v[112:115], v[96:99]
    s_add_u32 m0, s7, 121856
    ds_read_b64_tr_b16 v[18:19], v6 offset:28928
    buffer_load_dwordx4 v4, s[12:15], s43 offen offset:1024 lds
    v_mfma_f32_16x16x32_bf16 v[92:95], v[144:147], v[116:119], v[92:95]
    ds_read_b64_tr_b16 v[20:21], v7 offset:28672
    v_mfma_f32_16x16x32_bf16 v[100:103], v[148:151], v[116:119], v[100:103]
    ds_read_b64_tr_b16 v[22:23], v7 offset:28928
    s_waitcnt vmcnt(4)
    s_barrier
    s_waitcnt lgkmcnt(4)
    v_mfma_f32_16x16x32_bf16 v[72:75], v[120:123], v[152:155], v[72:75]
    ds_read_b128 v[160:163], v8 offset:32768
    ds_read_b64_tr_b16 v[104:105], v6 offset:32768
    v_mfma_f32_16x16x32_bf16 v[76:79], v[120:123], v[156:159], v[76:79]
    s_add_u32 m0, s7, 0
    ds_read_b64_tr_b16 v[106:107], v6 offset:33024
    buffer_load_dwordx4 v2, s[8:11], s36 offen lds
    v_mfma_f32_16x16x32_bf16 v[80:83], v[124:127], v[152:155], v[80:83]
    ds_read_b128 v[164:167], v8 offset:34816
    ds_read_b64_tr_b16 v[108:109], v7 offset:32768
    v_mfma_f32_16x16x32_bf16 v[84:87], v[124:127], v[156:159], v[84:87]
    ds_read_b64_tr_b16 v[110:111], v7 offset:33024
    s_waitcnt lgkmcnt(6)
    v_mfma_f32_16x16x32_bf16 v[88:91], v[152:155], v[16:19], v[88:91]
    ds_read_b64_tr_b16 v[112:113], v6 offset:40960
    v_mfma_f32_16x16x32_bf16 v[96:99], v[156:159], v[16:19], v[96:99]
    s_add_u32 m0, s7, 65536
    ds_read_b64_tr_b16 v[114:115], v6 offset:41216
    buffer_load_dwordx4 v4, s[12:15], s44 offen lds
    v_mfma_f32_16x16x32_bf16 v[92:95], v[152:155], v[20:23], v[92:95]
    ds_read_b64_tr_b16 v[116:117], v7 offset:40960
    v_mfma_f32_16x16x32_bf16 v[100:103], v[156:159], v[20:23], v[100:103]
    ds_read_b64_tr_b16 v[118:119], v7 offset:41216
    s_waitcnt lgkmcnt(4)
    v_mfma_f32_16x16x32_bf16 v[72:75], v[104:107], v[160:163], v[72:75]
    ds_read_b128 v[168:171], v9 offset:32768
    ds_read_b64_tr_b16 v[120:121], v6 offset:36864
    v_mfma_f32_16x16x32_bf16 v[76:79], v[104:107], v[164:167], v[76:79]
    s_add_u32 m0, s7, 8192
    ds_read_b64_tr_b16 v[122:123], v6 offset:37120
    buffer_load_dwordx4 v3, s[8:11], s36 offen lds
    v_mfma_f32_16x16x32_bf16 v[80:83], v[108:111], v[160:163], v[80:83]
    ds_read_b128 v[172:175], v9 offset:34816
    ds_read_b64_tr_b16 v[124:125], v7 offset:36864
    v_mfma_f32_16x16x32_bf16 v[84:87], v[108:111], v[164:167], v[84:87]
    ds_read_b64_tr_b16 v[126:127], v7 offset:37120
    s_waitcnt lgkmcnt(6)
    v_mfma_f32_16x16x32_bf16 v[88:91], v[160:163], v[112:115], v[88:91]
    ds_read_b64_tr_b16 v[16:17], v6 offset:45056
    v_mfma_f32_16x16x32_bf16 v[96:99], v[164:167], v[112:115], v[96:99]
    s_add_u32 m0, s7, 72704
    ds_read_b64_tr_b16 v[18:19], v6 offset:45312
    buffer_load_dwordx4 v4, s[12:15], s44 offen offset:1024 lds
    v_mfma_f32_16x16x32_bf16 v[92:95], v[160:163], v[116:119], v[92:95]
    ds_read_b64_tr_b16 v[20:21], v7 offset:45056
    v_mfma_f32_16x16x32_bf16 v[100:103], v[164:167], v[116:119], v[100:103]
    ds_read_b64_tr_b16 v[22:23], v7 offset:45312
    s_waitcnt vmcnt(4)
    s_barrier
    s_waitcnt lgkmcnt(4)
    v_mfma_f32_16x16x32_bf16 v[72:75], v[120:123], v[168:171], v[72:75]
    ds_read_b128 v[176:179], v8 offset:49152
    ds_read_b64_tr_b16 v[104:105], v6 offset:49152
    v_mfma_f32_16x16x32_bf16 v[76:79], v[120:123], v[172:175], v[76:79]
    s_add_u32 m0, s7, 16384
    ds_read_b64_tr_b16 v[106:107], v6 offset:49408
    buffer_load_dwordx4 v2, s[8:11], s37 offen lds
    v_mfma_f32_16x16x32_bf16 v[80:83], v[124:127], v[168:171], v[80:83]
    ds_read_b128 v[180:183], v8 offset:51200
    ds_read_b64_tr_b16 v[108:109], v7 offset:49152
    v_mfma_f32_16x16x32_bf16 v[84:87], v[124:127], v[172:175], v[84:87]
    ds_read_b64_tr_b16 v[110:111], v7 offset:49408
    s_waitcnt lgkmcnt(6)
    v_mfma_f32_16x16x32_bf16 v[88:91], v[168:171], v[16:19], v[88:91]
    ds_read_b64_tr_b16 v[112:113], v6 offset:57344
    v_mfma_f32_16x16x32_bf16 v[96:99], v[172:175], v[16:19], v[96:99]
    s_add_u32 m0, s7, 81920
    ds_read_b64_tr_b16 v[114:115], v6 offset:57600
    buffer_load_dwordx4 v4, s[12:15], s45 offen lds
    v_mfma_f32_16x16x32_bf16 v[92:95], v[168:171], v[20:23], v[92:95]
    ds_read_b64_tr_b16 v[116:117], v7 offset:57344
    v_mfma_f32_16x16x32_bf16 v[100:103], v[172:175], v[20:23], v[100:103]
    ds_read_b64_tr_b16 v[118:119], v7 offset:57600
    s_waitcnt lgkmcnt(4)
    v_mfma_f32_16x16x32_bf16 v[72:75], v[104:107], v[176:179], v[72:75]
    ds_read_b128 v[184:187], v9 offset:49152
    ds_read_b64_tr_b16 v[120:121], v6 offset:53248
    v_mfma_f32_16x16x32_bf16 v[76:79], v[104:107], v[180:183], v[76:79]
    s_add_u32 m0, s7, 24576
    ds_read_b64_tr_b16 v[122:123], v6 offset:53504
    buffer_load_dwordx4 v3, s[8:11], s37 offen lds
    v_mfma_f32_16x16x32_bf16 v[80:83], v[108:111], v[176:179], v[80:83]
    ds_read_b128 v[188:191], v9 offset:51200
    ds_read_b64_tr_b16 v[124:125], v7 offset:53248
    v_mfma_f32_16x16x32_bf16 v[84:87], v[108:111], v[180:183], v[84:87]
    ds_read_b64_tr_b16 v[126:127], v7 offset:53504
    s_waitcnt lgkmcnt(6)
    v_mfma_f32_16x16x32_bf16 v[88:91], v[176:179], v[112:115], v[88:91]
    ds_read_b64_tr_b16 v[16:17], v6 offset:61440
    v_mfma_f32_16x16x32_bf16 v[96:99], v[180:183], v[112:115], v[96:99]
    s_add_u32 m0, s7, 89088
    ds_read_b64_tr_b16 v[18:19], v6 offset:61696
    buffer_load_dwordx4 v4, s[12:15], s45 offen offset:1024 lds
    v_mfma_f32_16x16x32_bf16 v[92:95], v[176:179], v[116:119], v[92:95]
    ds_read_b64_tr_b16 v[20:21], v7 offset:61440
    v_mfma_f32_16x16x32_bf16 v[100:103], v[180:183], v[116:119], v[100:103]
    ds_read_b64_tr_b16 v[22:23], v7 offset:61696
    s_waitcnt vmcnt(4)
    s_barrier
    s_waitcnt lgkmcnt(4)
    v_mfma_f32_16x16x32_bf16 v[72:75], v[120:123], v[184:187], v[72:75]
    ds_read_b128 v[192:195], v8 offset:0
    ds_read_b64_tr_b16 v[104:105], v6 offset:0
    v_mfma_f32_16x16x32_bf16 v[76:79], v[120:123], v[188:191], v[76:79]
    s_add_u32 m0, s7, 32768
    ds_read_b64_tr_b16 v[106:107], v6 offset:256
    buffer_load_dwordx4 v2, s[8:11], s38 offen lds
    v_mfma_f32_16x16x32_bf16 v[80:83], v[124:127], v[184:187], v[80:83]
    ds_read_b128 v[196:199], v8 offset:2048
    ds_read_b64_tr_b16 v[108:109], v7 offset:0
    v_mfma_f32_16x16x32_bf16 v[84:87], v[124:127], v[188:191], v[84:87]
    ds_read_b64_tr_b16 v[110:111], v7 offset:256
    s_waitcnt lgkmcnt(6)
    v_mfma_f32_16x16x32_bf16 v[88:91], v[184:187], v[16:19], v[88:91]
    ds_read_b64_tr_b16 v[112:113], v6 offset:8192
    v_mfma_f32_16x16x32_bf16 v[96:99], v[188:191], v[16:19], v[96:99]
    s_add_u32 m0, s7, 98304
    ds_read_b64_tr_b16 v[114:115], v6 offset:8448
    buffer_load_dwordx4 v4, s[12:15], s46 offen lds
    v_mfma_f32_16x16x32_bf16 v[92:95], v[184:187], v[20:23], v[92:95]
    ds_read_b64_tr_b16 v[116:117], v7 offset:8192
    v_mfma_f32_16x16x32_bf16 v[100:103], v[188:191], v[20:23], v[100:103]
    ds_read_b64_tr_b16 v[118:119], v7 offset:8448
    s_waitcnt lgkmcnt(4)
    v_mfma_f32_16x16x32_bf16 v[72:75], v[104:107], v[192:195], v[72:75]
    ds_read_b128 v[200:203], v9 offset:0
    ds_read_b64_tr_b16 v[120:121], v6 offset:4096
    v_mfma_f32_16x16x32_bf16 v[76:79], v[104:107], v[196:199], v[76:79]
    s_add_u32 m0, s7, 40960
    ds_read_b64_tr_b16 v[122:123], v6 offset:4352
    buffer_load_dwordx4 v3, s[8:11], s38 offen lds
    v_mfma_f32_16x16x32_bf16 v[80:83], v[108:111], v[192:195], v[80:83]
    ds_read_b128 v[204:207], v9 offset:2048
    ds_read_b64_tr_b16 v[124:125], v7 offset:4096
    v_mfma_f32_16x16x32_bf16 v[84:87], v[108:111], v[196:199], v[84:87]
    ds_read_b64_tr_b16 v[126:127], v7 offset:4352
    s_waitcnt lgkmcnt(6)
    v_mfma_f32_16x16x32_bf16 v[88:91], v[192:195], v[112:115], v[88:91]
    ds_read_b64_tr_b16 v[16:17], v6 offset:12288
    v_mfma_f32_16x16x32_bf16 v[96:99], v[196:199], v[112:115], v[96:99]
    s_add_u32 m0, s7, 105472
    ds_read_b64_tr_b16 v[18:19], v6 offset:12544
    buffer_load_dwordx4 v4, s[12:15], s46 offen offset:1024 lds
    v_mfma_f32_16x16x32_bf16 v[92:95], v[192:195], v[116:119], v[92:95]
    ds_read_b64_tr_b16 v[20:21], v7 offset:12288
    v_mfma_f32_16x16x32_bf16 v[100:103], v[196:199], v[116:119], v[100:103]
    ds_read_b64_tr_b16 v[22:23], v7 offset:12544
    s_waitcnt vmcnt(4)
    s_barrier
    s_waitcnt lgkmcnt(4)
    v_mfma_f32_16x16x32_bf16 v[72:75], v[120:123], v[200:203], v[72:75]
    ds_read_b128 v[208:211], v8 offset:16384
    ds_read_b64_tr_b16 v[104:105], v6 offset:16384
    v_mfma_f32_16x16x32_bf16 v[76:79], v[120:123], v[204:207], v[76:79]
    s_add_u32 m0, s7, 49152
    ds_read_b64_tr_b16 v[106:107], v6 offset:16640
    buffer_load_dwordx4 v2, s[8:11], s39 offen lds
    v_mfma_f32_16x16x32_bf16 v[80:83], v[124:127], v[200:203], v[80:83]
    ds_read_b128 v[212:215], v8 offset:18432
    ds_read_b64_tr_b16 v[108:109], v7 offset:16384
    v_mfma_f32_16x16x32_bf16 v[84:87], v[124:127], v[204:207], v[84:87]
    ds_read_b64_tr_b16 v[110:111], v7 offset:16640
    s_waitcnt lgkmcnt(6)
    v_mfma_f32_16x16x32_bf16 v[88:91], v[200:203], v[16:19], v[88:91]
    ds_read_b64_tr_b16 v[112:113], v6 offset:24576
    v_mfma_f32_16x16x32_bf16 v[96:99], v[204:207], v[16:19], v[96:99]
    s_add_u32 m0, s7, 114688
    ds_read_b64_tr_b16 v[114:115], v6 offset:24832
    buffer_load_dwordx4 v4, s[12:15], s47 offen lds
    v_mfma_f32_16x16x32_bf16 v[92:95], v[200:203], v[20:23], v[92:95]
    ds_read_b64_tr_b16 v[116:117], v7 offset:24576
    v_mfma_f32_16x16x32_bf16 v[100:103], v[204:207], v[20:23], v[100:103]
    ds_read_b64_tr_b16 v[118:119], v7 offset:24832
    s_waitcnt lgkmcnt(4)
    v_mfma_f32_16x16x32_bf16 v[72:75], v[104:107], v[208:211], v[72:75]
    ds_read_b128 v[216:219], v9 offset:16384
    ds_read_b64_tr_b16 v[120:121], v6 offset:20480
    v_mfma_f32_16x16x32_bf16 v[76:79], v[104:107], v[212:215], v[76:79]
    s_add_u32 m0, s7, 57344
    ds_read_b64_tr_b16 v[122:123], v6 offset:20736
    buffer_load_dwordx4 v3, s[8:11], s39 offen lds
    v_mfma_f32_16x16x32_bf16 v[80:83], v[108:111], v[208:211], v[80:83]
    ds_read_b128 v[220:223], v9 offset:18432
    ds_read_b64_tr_b16 v[124:125], v7 offset:20480
    v_mfma_f32_16x16x32_bf16 v[84:87], v[108:111], v[212:215], v[84:87]
    ds_read_b64_tr_b16 v[126:127], v7 offset:20736
    s_waitcnt lgkmcnt(6)
    v_mfma_f32_16x16x32_bf16 v[88:91], v[208:211], v[112:115], v[88:91]
    ds_read_b64_tr_b16 v[16:17], v6 offset:28672
    v_mfma_f32_16x16x32_bf16 v[96:99], v[212:215], v[112:115], v[96:99]
    s_add_u32 m0, s7, 121856
    ds_read_b64_tr_b16 v[18:19], v6 offset:28928
    buffer_load_dwordx4 v4, s[12:15], s47 offen offset:1024 lds
    v_mfma_f32_16x16x32_bf16 v[92:95], v[208:211], v[116:119], v[92:95]
    ds_read_b64_tr_b16 v[20:21], v7 offset:28672
    v_mfma_f32_16x16x32_bf16 v[100:103], v[212:215], v[116:119], v[100:103]
    ds_read_b64_tr_b16 v[22:23], v7 offset:28928
    v_subrev_u32 v4, 0x400, v4
    s_waitcnt vmcnt(4)
    s_barrier
    s_waitcnt lgkmcnt(4)
    v_mfma_f32_16x16x32_bf16 v[72:75], v[120:123], v[216:219], v[72:75]
    ds_read_b128 v[224:227], v8 offset:32768
    ds_read_b64_tr_b16 v[104:105], v6 offset:32768
    v_mfma_f32_16x16x32_bf16 v[76:79], v[120:123], v[220:223], v[76:79]
    s_add_u32 m0, s7, 65536
    ds_read_b64_tr_b16 v[106:107], v6 offset:33024
    buffer_load_dwordx4 v4, s[12:15], s40 offen lds
    v_mfma_f32_16x16x32_bf16 v[80:83], v[124:127], v[216:219], v[80:83]
    ds_read_b128 v[228:231], v8 offset:34816
    ds_read_b64_tr_b16 v[108:109], v7 offset:32768
    v_mfma_f32_16x16x32_bf16 v[84:87], v[124:127], v[220:223], v[84:87]
    ds_read_b64_tr_b16 v[110:111], v7 offset:33024
    s_waitcnt lgkmcnt(6)
    v_mfma_f32_16x16x32_bf16 v[88:91], v[216:219], v[16:19], v[88:91]
    ds_read_b64_tr_b16 v[112:113], v6 offset:40960
    v_mfma_f32_16x16x32_bf16 v[96:99], v[220:223], v[16:19], v[96:99]
    s_add_u32 m0, s7, 73728
    ds_read_b64_tr_b16 v[114:115], v6 offset:41216
    buffer_load_dwordx4 v4, s[12:15], s41 offen lds
    v_mfma_f32_16x16x32_bf16 v[92:95], v[216:219], v[20:23], v[92:95]
    ds_read_b64_tr_b16 v[116:117], v7 offset:40960
    v_mfma_f32_16x16x32_bf16 v[100:103], v[220:223], v[20:23], v[100:103]
    ds_read_b64_tr_b16 v[118:119], v7 offset:41216
    s_mov_b64 s[8:9], s[24:25]
    s_lshl_b32 s50, s3, 2
    s_or_b32 s50, s50, s56
    s_waitcnt lgkmcnt(4)
    v_mfma_f32_16x16x32_bf16 v[72:75], v[104:107], v[224:227], v[72:75]
    ds_read_b128 v[232:235], v9 offset:32768
    ds_read_b64_tr_b16 v[120:121], v6 offset:36864
    v_mfma_f32_16x16x32_bf16 v[76:79], v[104:107], v[228:231], v[76:79]
    s_add_u32 m0, s7, 0
    ds_read_b64_tr_b16 v[122:123], v6 offset:37120
    buffer_load_dwordx4 v4, s[12:15], s44 offen lds
    v_mfma_f32_16x16x32_bf16 v[80:83], v[108:111], v[224:227], v[80:83]
    ds_read_b128 v[236:239], v9 offset:34816
    ds_read_b64_tr_b16 v[124:125], v7 offset:36864
    v_mfma_f32_16x16x32_bf16 v[84:87], v[108:111], v[228:231], v[84:87]
    ds_read_b64_tr_b16 v[126:127], v7 offset:37120
    s_cmp_ge_u32 s50, 3
    s_cselect_b32 s10, s26, 0
    s_waitcnt lgkmcnt(6)
    v_mfma_f32_16x16x32_bf16 v[88:91], v[224:227], v[112:115], v[88:91]
    ds_read_b64_tr_b16 v[16:17], v6 offset:45056
    v_mfma_f32_16x16x32_bf16 v[96:99], v[228:231], v[112:115], v[96:99]
    s_add_u32 m0, s7, 8192
    ds_read_b64_tr_b16 v[18:19], v6 offset:45312
    buffer_load_dwordx4 v4, s[12:15], s45 offen lds
    v_mfma_f32_16x16x32_bf16 v[92:95], v[224:227], v[116:119], v[92:95]
    ds_read_b64_tr_b16 v[20:21], v7 offset:45056
    v_mfma_f32_16x16x32_bf16 v[100:103], v[228:231], v[116:119], v[100:103]
    ds_read_b64_tr_b16 v[22:23], v7 offset:45312
    s_waitcnt vmcnt(4)
    s_barrier
    s_waitcnt lgkmcnt(4)
    v_mfma_f32_16x16x32_bf16 v[72:75], v[120:123], v[232:235], v[72:75]
    ds_read_b128 v[240:243], v8 offset:49152
    ds_read_b64_tr_b16 v[104:105], v6 offset:49152
    v_mfma_f32_16x16x32_bf16 v[76:79], v[120:123], v[236:239], v[76:79]
    s_add_u32 m0, s7, 81920
    ds_read_b64_tr_b16 v[106:107], v6 offset:49408
    buffer_load_dwordx4 v4, s[12:15], s42 offen lds
    v_mfma_f32_16x16x32_bf16 v[80:83], v[124:127], v[232:235], v[80:83]
    ds_read_b128 v[244:247], v8 offset:51200
    ds_read_b64_tr_b16 v[108:109], v7 offset:49152
    v_mfma_f32_16x16x32_bf16 v[84:87], v[124:127], v[236:239], v[84:87]
    ds_read_b64_tr_b16 v[110:111], v7 offset:49408
    s_waitcnt lgkmcnt(6)
    v_mfma_f32_16x16x32_bf16 v[88:91], v[232:235], v[16:19], v[88:91]
    ds_read_b64_tr_b16 v[112:113], v6 offset:57344
    v_mfma_f32_16x16x32_bf16 v[96:99], v[236:239], v[16:19], v[96:99]
    s_add_u32 m0, s7, 90112
    ds_read_b64_tr_b16 v[114:115], v6 offset:57600
    buffer_load_dwordx4 v4, s[12:15], s43 offen lds
    v_mfma_f32_16x16x32_bf16 v[92:95], v[232:235], v[20:23], v[92:95]
    ds_read_b64_tr_b16 v[116:117], v7 offset:57344
    v_mfma_f32_16x16x32_bf16 v[100:103], v[236:239], v[20:23], v[100:103]
    ds_read_b64_tr_b16 v[118:119], v7 offset:57600
    s_waitcnt lgkmcnt(4)
    v_mfma_f32_16x16x32_bf16 v[72:75], v[104:107], v[240:243], v[72:75]
    ds_read_b128 v[248:251], v9 offset:49152
    ds_read_b64_tr_b16 v[120:121], v6 offset:53248
    v_mfma_f32_16x16x32_bf16 v[76:79], v[104:107], v[244:247], v[76:79]
    s_add_u32 m0, s7, 16384
    ds_read_b64_tr_b16 v[122:123], v6 offset:53504
    buffer_load_dwordx4 v4, s[12:15], s46 offen lds
    v_mfma_f32_16x16x32_bf16 v[80:83], v[108:111], v[240:243], v[80:83]
    ds_read_b128 v[252:255], v9 offset:51200
    ds_read_b64_tr_b16 v[124:125], v7 offset:53248
    v_mfma_f32_16x16x32_bf16 v[84:87], v[108:111], v[244:247], v[84:87]
    ds_read_b64_tr_b16 v[126:127], v7 offset:53504
    s_waitcnt lgkmcnt(6)
    v_mfma_f32_16x16x32_bf16 v[88:91], v[240:243], v[112:115], v[88:91]
    ds_read_b64_tr_b16 v[16:17], v6 offset:61440
    v_mfma_f32_16x16x32_bf16 v[96:99], v[244:247], v[112:115], v[96:99]
    s_add_u32 m0, s7, 24576
    ds_read_b64_tr_b16 v[18:19], v6 offset:61696
    buffer_load_dwordx4 v4, s[12:15], s47 offen lds
    v_mfma_f32_16x16x32_bf16 v[92:95], v[240:243], v[116:119], v[92:95]
    ds_read_b64_tr_b16 v[20:21], v7 offset:61440
    v_mfma_f32_16x16x32_bf16 v[100:103], v[244:247], v[116:119], v[100:103]
    ds_read_b64_tr_b16 v[22:23], v7 offset:61696
    s_waitcnt vmcnt(6)
    s_barrier
    s_setprio 3
    s_waitcnt lgkmcnt(4)
    v_mfma_f32_16x16x32_bf16 v[72:75], v[120:123], v[248:251], v[72:75]
    ds_read_b64_tr_b16 v[104:105], v6 offset:0
    v_mfma_f32_16x16x32_bf16 v[76:79], v[120:123], v[252:255], v[76:79]
    ds_read_b64_tr_b16 v[106:107], v6 offset:256
    buffer_load_dwordx2 v[14:15], off, s[28:31], 0 sc1
    v_mfma_f32_16x16x32_bf16 v[80:83], v[124:127], v[248:251], v[80:83]
    ds_read_b64_tr_b16 v[108:109], v7 offset:0
    v_mfma_f32_16x16x32_bf16 v[84:87], v[124:127], v[252:255], v[84:87]
    ds_read_b64_tr_b16 v[110:111], v7 offset:256
    s_mov_b32 exec_hi, 0
    buffer_store_dwordx2 v[12:13], v13, s[24:27], s69 offen sc1
    s_mov_b32 exec_hi, -1
    s_setprio 2
    s_waitcnt lgkmcnt(4)
    v_mfma_f32_16x16x32_bf16 v[88:91], v[248:251], v[16:19], v[88:91]
    ds_read_b64_tr_b16 v[112:113], v6 offset:4096
    v_mfma_f32_16x16x32_bf16 v[96:99], v[252:255], v[16:19], v[96:99]
    ds_read_b64_tr_b16 v[114:115], v6 offset:4352
    v_mfma_f32_16x16x32_bf16 v[92:95], v[248:251], v[20:23], v[92:95]
    ds_read_b64_tr_b16 v[116:117], v7 offset:4096
    v_mfma_f32_16x16x32_bf16 v[100:103], v[252:255], v[20:23], v[100:103]
    ds_read_b64_tr_b16 v[118:119], v7 offset:4352
    v_cvt_pk_bf16_f32 v72, v72, v73
    v_cvt_pk_bf16_f32 v73, v74, v75
    v_cvt_pk_bf16_f32 v74, v76, v77
    v_cvt_pk_bf16_f32 v75, v78, v79
    s_nop 0
    v_permlane16_swap_b32 v72, v74
    v_permlane16_swap_b32 v73, v75
    buffer_store_dwordx4 v[72:75], v12, s[8:11], s1 offen offset:0 sc1
    s_setprio 1
    s_waitcnt lgkmcnt(4)
    v_mfma_f32_16x16x32_bf16 v[24:27], v[104:107], v[128:131], 0
    ds_read_b64_tr_b16 v[120:121], v6 offset:8192
    v_mfma_f32_16x16x32_bf16 v[28:31], v[104:107], v[132:135], 0
    ds_read_b64_tr_b16 v[122:123], v6 offset:8448
    v_cvt_pk_bf16_f32 v76, v80, v81
    v_cvt_pk_bf16_f32 v77, v82, v83
    v_cvt_pk_bf16_f32 v78, v84, v85
    v_cvt_pk_bf16_f32 v79, v86, v87
    s_nop 0
    v_permlane16_swap_b32 v76, v78
    v_permlane16_swap_b32 v77, v79
    buffer_store_dwordx4 v[76:79], v12, s[8:11], s1 offen offset:1024 sc1
    v_mfma_f32_16x16x32_bf16 v[32:35], v[108:111], v[128:131], 0
    ds_read_b64_tr_b16 v[124:125], v7 offset:8192
    v_mfma_f32_16x16x32_bf16 v[36:39], v[108:111], v[132:135], 0
    ds_read_b64_tr_b16 v[126:127], v7 offset:8448
    v_cvt_pk_bf16_f32 v88, v88, v89
    v_cvt_pk_bf16_f32 v89, v90, v91
    v_cvt_pk_bf16_f32 v90, v92, v93
    v_cvt_pk_bf16_f32 v91, v94, v95
    s_nop 0
    v_permlane16_swap_b32 v88, v90
    v_permlane16_swap_b32 v89, v91
    s_nop 0
    v_permlane32_swap_b32 v88, v90
    v_permlane32_swap_b32 v89, v91
    s_add_u32 s1, s1, 4096
    buffer_store_dwordx4 v[88:91], v12, s[8:11], s1 offen offset:0 sc1
    s_setprio 0
    s_waitcnt lgkmcnt(4)
    v_mfma_f32_16x16x32_bf16 v[24:27], v[112:115], v[136:139], v[24:27]
    ds_read_b64_tr_b16 v[16:17], v6 offset:12288
    v_mfma_f32_16x16x32_bf16 v[28:31], v[112:115], v[140:143], v[28:31]
    ds_read_b64_tr_b16 v[18:19], v6 offset:12544
    v_cvt_pk_bf16_f32 v92, v96, v97
    v_cvt_pk_bf16_f32 v93, v98, v99
    v_cvt_pk_bf16_f32 v94, v100, v101
    v_cvt_pk_bf16_f32 v95, v102, v103
    s_nop 0
    v_permlane16_swap_b32 v92, v94
    v_permlane16_swap_b32 v93, v95
    s_nop 0
    v_permlane32_swap_b32 v92, v94
    v_permlane32_swap_b32 v93, v95
    buffer_store_dwordx4 v[92:95], v12, s[8:11], s1 offen offset:1024 sc1
    v_mfma_f32_16x16x32_bf16 v[32:35], v[116:119], v[136:139], v[32:35]
    ds_read_b64_tr_b16 v[20:21], v7 offset:12288
    v_mfma_f32_16x16x32_bf16 v[36:39], v[116:119], v[140:143], v[36:39]
    ds_read_b64_tr_b16 v[22:23], v7 offset:12544
    s_waitcnt vmcnt(6)
    s_barrier
    s_setprio 3
    s_waitcnt lgkmcnt(4)
    v_mfma_f32_16x16x32_bf16 v[24:27], v[120:123], v[144:147], v[24:27]
    ds_read_b64_tr_b16 v[104:105], v6 offset:16384
    v_mfma_f32_16x16x32_bf16 v[28:31], v[120:123], v[148:151], v[28:31]
    ds_read_b64_tr_b16 v[106:107], v6 offset:16640
    v_mfma_f32_16x16x32_bf16 v[32:35], v[124:127], v[144:147], v[32:35]
    ds_read_b64_tr_b16 v[108:109], v7 offset:16384
    v_mfma_f32_16x16x32_bf16 v[36:39], v[124:127], v[148:151], v[36:39]
    ds_read_b64_tr_b16 v[110:111], v7 offset:16640
    s_waitcnt lgkmcnt(4)
    v_mfma_f32_16x16x32_bf16 v[24:27], v[16:19], v[152:155], v[24:27]
    ds_read_b64_tr_b16 v[112:113], v6 offset:20480
    v_mfma_f32_16x16x32_bf16 v[28:31], v[16:19], v[156:159], v[28:31]
    ds_read_b64_tr_b16 v[114:115], v6 offset:20736
    s_setprio 2
    v_mfma_f32_16x16x32_bf16 v[32:35], v[20:23], v[152:155], v[32:35]
    ds_read_b64_tr_b16 v[116:117], v7 offset:20480
    v_mfma_f32_16x16x32_bf16 v[36:39], v[20:23], v[156:159], v[36:39]
    ds_read_b64_tr_b16 v[118:119], v7 offset:20736
    ds_write_b128 v0, v[72:75] offset:0
    s_waitcnt lgkmcnt(5)
    v_mfma_f32_16x16x32_bf16 v[24:27], v[104:107], v[160:163], v[24:27]
    ds_read_b64_tr_b16 v[120:121], v6 offset:24576
    v_mfma_f32_16x16x32_bf16 v[28:31], v[104:107], v[164:167], v[28:31]
    ds_read_b64_tr_b16 v[122:123], v6 offset:24832
    s_waitcnt vmcnt(5)
    v_readfirstlane_b32 s48, v14
    v_readfirstlane_b32 s49, v15
    s_nop 0
    s_cmp_eq_u32 s49, 0
    s_cbranch_scc1 L_c_2
L_c_2r:
    v_mfma_f32_16x16x32_bf16 v[32:35], v[108:111], v[160:163], v[32:35]
    ds_read_b64_tr_b16 v[124:125], v7 offset:24576
    v_mfma_f32_16x16x32_bf16 v[36:39], v[108:111], v[164:167], v[36:39]
    ds_read_b64_tr_b16 v[126:127], v7 offset:24832
    ds_write_b128 v0, v[76:79] offset:1024
    s_setprio 1
    s_waitcnt lgkmcnt(6)
    v_mfma_f32_16x16x32_bf16 v[24:27], v[112:115], v[168:171], v[24:27]
    ds_read_b64_tr_b16 v[16:17], v6 offset:28672
    v_mfma_f32_16x16x32_bf16 v[28:31], v[112:115], v[172:175], v[28:31]
    ds_read_b64_tr_b16 v[18:19], v6 offset:28928
    s_waitcnt vmcnt(2)
    s_mov_b64 exec, 0xffff
    buffer_store_dwordx2 v[14:15], v13, s[8:11], s0 offen sc1
    s_mov_b64 exec, -1
    v_mfma_f32_16x16x32_bf16 v[32:35], v[116:119], v[168:171], v[32:35]
    ds_read_b64_tr_b16 v[20:21], v7 offset:28672
    v_mfma_f32_16x16x32_bf16 v[36:39], v[116:119], v[172:175], v[36:39]
    ds_read_b64_tr_b16 v[22:23], v7 offset:28928
    ds_write_b128 v0, v[88:91] offset:4096
    v_xor_b32 v6, 32, v5
    s_waitcnt lgkmcnt(6)
    v_mfma_f32_16x16x32_bf16 v[24:27], v[120:123], v[176:179], v[24:27]
    ds_read_b64_tr_b16 v[104:105], v5 offset:0
    v_mfma_f32_16x16x32_bf16 v[28:31], v[120:123], v[180:183], v[28:31]
    ds_read_b64_tr_b16 v[106:107], v5 offset:256
    s_mov_b64 s[12:13], s[24:25]
    s_cmp_lg_u32 s66, 0
    s_cselect_b32 s14, 0, s26
    s_setprio 0
    v_mfma_f32_16x16x32_bf16 v[32:35], v[124:127], v[176:179], v[32:35]
    ds_read_b64_tr_b16 v[108:109], v6 offset:0
    v_mfma_f32_16x16x32_bf16 v[36:39], v[124:127], v[180:183], v[36:39]
    ds_read_b64_tr_b16 v[110:111], v6 offset:256
    ds_write_b128 v0, v[92:95] offset:5120
    s_waitcnt lgkmcnt(6)
    v_mfma_f32_16x16x32_bf16 v[24:27], v[16:19], v[184:187], v[24:27]
    ds_read_b64_tr_b16 v[112:113], v5 offset:4096
    v_mfma_f32_16x16x32_bf16 v[28:31], v[16:19], v[188:191], v[28:31]
    ds_read_b64_tr_b16 v[114:115], v5 offset:4352
    v_add_u32 v0, 0xffff0000, v0
    v_add_u32 v2, 0x2000, v0
    v_and_b32 v7, 0xfffffeff, v0
    v_mfma_f32_16x16x32_bf16 v[32:35], v[20:23], v[184:187], v[32:35]
    ds_read_b64_tr_b16 v[116:117], v6 offset:4096
    v_mfma_f32_16x16x32_bf16 v[36:39], v[20:23], v[188:191], v[36:39]
    ds_read_b64_tr_b16 v[118:119], v6 offset:4352
    v_add_u32 v7, 0x1000, v7
    v_add_u32 v3, 0x2000, v7
    s_waitcnt lgkmcnt(4)
    s_barrier
    s_setprio 3
    v_mfma_f32_16x16x32_bf16 v[24:27], v[104:107], v[192:195], v[24:27]
    ds_read_b64_tr_b16 v[120:121], v5 offset:8192
    v_mfma_f32_16x16x32_bf16 v[28:31], v[104:107], v[196:199], v[28:31]
    ds_read_b64_tr_b16 v[122:123], v5 offset:8448
    v_mfma_f32_16x16x32_bf16 v[32:35], v[108:111], v[192:195], v[32:35]
    ds_read_b64_tr_b16 v[124:125], v6 offset:8192
    v_mfma_f32_16x16x32_bf16 v[36:39], v[108:111], v[196:199], v[36:39]
    ds_read_b64_tr_b16 v[126:127], v6 offset:8448
    s_waitcnt lgkmcnt(4)
    v_mfma_f32_16x16x32_bf16 v[24:27], v[112:115], v[200:203], v[24:27]
    ds_read_b64_tr_b16 v[16:17], v5 offset:12288
    v_mfma_f32_16x16x32_bf16 v[28:31], v[112:115], v[204:207], v[28:31]
    ds_read_b64_tr_b16 v[18:19], v5 offset:12544
    s_mov_b64 exec, 3
    buffer_load_dwordx2 v[8:9], v10, s[12:15], s65 offen sc1
    s_mov_b64 exec, -1
    v_mov_b32 v144, v11
    v_mov_b32 v145, v11
    v_mfma_f32_16x16x32_bf16 v[32:35], v[116:119], v[200:203], v[32:35]
    ds_read_b64_tr_b16 v[20:21], v6 offset:12288
    v_mfma_f32_16x16x32_bf16 v[36:39], v[116:119], v[204:207], v[36:39]
    ds_read_b64_tr_b16 v[22:23], v6 offset:12544
    s_add_u32 s0, s0, 262144
    s_waitcnt vmcnt(2)
    s_mov_b64 exec, 0xffff
    buffer_store_dwordx2 v[14:15], v13, s[8:11], s0 offen sc1
    s_mov_b64 exec, -1
    v_mov_b32 v146, v11
    v_mov_b32 v147, v11
    s_setprio 2
    s_waitcnt lgkmcnt(4)
    v_mfma_f32_16x16x32_bf16 v[24:27], v[120:123], v[208:211], v[24:27]
    ds_read_b64_tr_b16 v[104:105], v5 offset:16384
    v_mfma_f32_16x16x32_bf16 v[28:31], v[120:123], v[212:215], v[28:31]
    ds_read_b64_tr_b16 v[106:107], v5 offset:16640
    v_mov_b32 v148, v11
    v_mov_b32 v149, v11
    v_mfma_f32_16x16x32_bf16 v[32:35], v[124:127], v[208:211], v[32:35]
    ds_read_b64_tr_b16 v[108:109], v6 offset:16384
    v_mfma_f32_16x16x32_bf16 v[36:39], v[124:127], v[212:215], v[36:39]
    ds_read_b64_tr_b16 v[110:111], v6 offset:16640
    v_mov_b32 v150, v11
    v_mov_b32 v151, v11
    s_waitcnt lgkmcnt(4)
    v_mfma_f32_16x16x32_bf16 v[24:27], v[16:19], v[216:219], v[24:27]
    ds_read_b64_tr_b16 v[112:113], v5 offset:20480
    v_mfma_f32_16x16x32_bf16 v[28:31], v[16:19], v[220:223], v[28:31]
    ds_read_b64_tr_b16 v[114:115], v5 offset:20736
    v_mov_b32 v152, v11
    v_mov_b32 v153, v11
    v_mfma_f32_16x16x32_bf16 v[32:35], v[20:23], v[216:219], v[32:35]
    ds_read_b64_tr_b16 v[116:117], v6 offset:20480
    v_mfma_f32_16x16x32_bf16 v[36:39], v[20:23], v[220:223], v[36:39]
    ds_read_b64_tr_b16 v[118:119], v6 offset:20736
    v_mov_b32 v154, v11
    v_mov_b32 v155, v11
    s_setprio 1
    s_waitcnt lgkmcnt(4)
    v_mfma_f32_16x16x32_bf16 v[24:27], v[104:107], v[224:227], v[24:27]
    ds_read_b64_tr_b16 v[120:121], v5 offset:24576
    v_mfma_f32_16x16x32_bf16 v[28:31], v[104:107], v[228:231], v[28:31]
    ds_read_b64_tr_b16 v[122:123], v5 offset:24832
    v_mov_b32 v156, v11
    v_mov_b32 v157, v11
    ds_read_b128 v[136:139], v2 offset:58368
    ds_read_b128 v[140:143], v2 offset:57344
    v_mfma_f32_16x16x32_bf16 v[32:35], v[108:111], v[224:227], v[32:35]
    ds_read_b64_tr_b16 v[124:125], v6 offset:24576
    v_mfma_f32_16x16x32_bf16 v[36:39], v[108:111], v[228:231], v[36:39]
    ds_read_b64_tr_b16 v[126:127], v6 offset:24832
    v_mov_b32 v158, v11
    v_mov_b32 v159, v11
    s_waitcnt lgkmcnt(6)
    v_mfma_f32_16x16x32_bf16 v[24:27], v[112:115], v[232:235], v[24:27]
    ds_read_b64_tr_b16 v[16:17], v5 offset:28672
    v_mfma_f32_16x16x32_bf16 v[28:31], v[112:115], v[236:239], v[28:31]
    ds_read_b64_tr_b16 v[18:19], v5 offset:28928
    v_mov_b32 v160, v11
    v_mov_b32 v161, v11
    v_mfma_f32_16x16x32_bf16 v[32:35], v[116:119], v[232:235], v[32:35]
    ds_read_b64_tr_b16 v[20:21], v6 offset:28672
    v_mfma_f32_16x16x32_bf16 v[36:39], v[116:119], v[236:239], v[36:39]
    ds_read_b64_tr_b16 v[22:23], v6 offset:28928
    v_mov_b32 v162, v11
    v_mov_b32 v163, v11
    s_cmp_eq_u32 s3, 0
    s_cbranch_scc1 L_nov
    s_waitcnt vmcnt(1)
    v_cmp_ne_u64 vcc, s[48:49], v[8:9]
    s_and_b32 s50, vcc_lo, 3
    s_cselect_b32 s67, s14, 0
    s_cmp_lg_u32 s67, 0
    s_cbranch_scc1 L_nov
    s_lshl_b32 s51, s6, 13
    s_add_u32 m0, s51, 65536
    s_add_u32 s50, s64, 0
    buffer_load_dwordx4 v12, s[12:15], s50 offen offset:0 sc1 lds
    buffer_load_dwordx4 v12, s[12:15], s50 offen offset:1024 sc1 lds
    buffer_load_dwordx4 v12, s[12:15], s50 offen offset:2048 sc1 lds
    buffer_load_dwordx4 v12, s[12:15], s50 offen offset:3072 sc1 lds
L_nov:
    s_setprio 0
    s_waitcnt lgkmcnt(4)
    v_mfma_f32_16x16x32_bf16 v[24:27], v[120:123], v[240:243], v[24:27]
    v_mfma_f32_16x16x32_bf16 v[28:31], v[120:123], v[244:247], v[28:31]
    v_mov_b32 v164, v11
    v_mov_b32 v165, v11
    v_mfma_f32_16x16x32_bf16 v[32:35], v[124:127], v[240:243], v[32:35]
    v_mfma_f32_16x16x32_bf16 v[36:39], v[124:127], v[244:247], v[36:39]
    v_mov_b32 v166, v11
    v_mov_b32 v167, v11
    s_waitcnt lgkmcnt(0)
    v_mfma_f32_16x16x32_bf16 v[24:27], v[16:19], v[248:251], v[24:27]
    v_mfma_f32_16x16x32_bf16 v[28:31], v[16:19], v[252:255], v[28:31]
    s_mov_b64 exec, 12
    buffer_load_dwordx2 v[8:9], v10, s[12:15], s65 offen sc1
    s_mov_b64 exec, -1
    v_mfma_f32_16x16x32_bf16 v[32:35], v[20:23], v[248:251], v[32:35]
    v_mfma_f32_16x16x32_bf16 v[36:39], v[20:23], v[252:255], v[36:39]
    s_mov_b32 s52, 0x3eb8aa3b
    s_mov_b32 s53, 0x3eb8aa3b
    s_cmp_eq_u32 s3, 0
    s_cbranch_scc1 L_attnA
    s_cmp_lg_u32 s67, 0
    s_cbranch_scc1 L_c_3
L_c_3r:
    s_nop 3
    v_pk_mul_f32 v[32:33], v[32:33], s[52:53]
    v_pk_mul_f32 v[34:35], v[34:35], s[52:53]
    v_pk_mul_f32 v[36:37], v[36:37], s[52:53]
    v_pk_mul_f32 v[38:39], v[38:39], s[52:53]
    v_cvt_pk_bf16_f32 v20, v32, v33
    v_cvt_pk_bf16_f32 v22, v36, v37
    v_cvt_pk_bf16_f32 v21, v34, v35
    v_cvt_pk_bf16_f32 v23, v38, v39
    s_nop 0
    v_permlane16_swap_b32 v20, v22
    v_permlane16_swap_b32 v21, v23
    v_pk_mul_f32 v[24:25], v[24:25], s[52:53]
    v_pk_mul_f32 v[26:27], v[26:27], s[52:53]
    v_pk_mul_f32 v[28:29], v[28:29], s[52:53]
    v_pk_mul_f32 v[30:31], v[30:31], s[52:53]
    v_cvt_pk_bf16_f32 v16, v24, v25
    v_cvt_pk_bf16_f32 v18, v28, v29
    v_cvt_pk_bf16_f32 v17, v26, v27
    v_cvt_pk_bf16_f32 v19, v30, v31
    s_nop 0
    v_permlane16_swap_b32 v16, v18
    v_permlane16_swap_b32 v17, v19
    v_mfma_f32_32x32x16_bf16 v[72:87], v[136:139], v[20:23], v[40:55]
    s_nop 0
    s_nop 6
    s_setprio 1
    s_mov_b64 exec, s[60:61]
    ds_read_b128 v[144:147], v3 offset:57600
    ds_read_b128 v[148:151], v3 offset:58624
    s_mov_b64 exec, -1
    v_exp_f32 v72, v72
    v_exp_f32 v73, v73
    v_exp_f32 v74, v74
    v_exp_f32 v75, v75
    v_exp_f32 v76, v76
    v_exp_f32 v77, v77
    v_exp_f32 v78, v78
    v_exp_f32 v79, v79
    v_mfma_f32_32x32x16_bf16 v[88:103], v[140:143], v[16:19], v[40:55]
    v_cvt_pk_bf16_f32 v176, v72, v73
    v_cvt_pk_bf16_f32 v177, v74, v75
    v_cvt_pk_bf16_f32 v178, v76, v77
    v_cvt_pk_bf16_f32 v179, v78, v79
    v_exp_f32 v80, v80
    v_exp_f32 v81, v81
    v_exp_f32 v82, v82
    v_exp_f32 v83, v83
    v_exp_f32 v84, v84
    v_exp_f32 v85, v85
    v_exp_f32 v86, v86
    v_exp_f32 v87, v87
    v_cvt_pk_bf16_f32 v180, v80, v81
    v_cvt_pk_bf16_f32 v181, v82, v83
    v_cvt_pk_bf16_f32 v182, v84, v85
    v_cvt_pk_bf16_f32 v183, v86, v87
    s_setprio 0
    s_mov_b64 exec, s[60:61]
    ds_read_b128 v[152:155], v3 offset:57344
    ds_read_b128 v[156:159], v3 offset:58368
    s_mov_b64 exec, -1
    v_exp_f32 v88, v88
    v_exp_f32 v89, v89
    v_exp_f32 v90, v90
    v_exp_f32 v91, v91
    s_waitcnt lgkmcnt(2)
    v_mfma_f32_32x32x16_bf16 v[120:135], v[144:147], v[176:179], 0
    v_exp_f32 v92, v92
    v_exp_f32 v93, v93
    v_exp_f32 v94, v94
    v_exp_f32 v95, v95
    v_mfma_f32_32x32x16_bf16 v[120:135], v[148:151], v[180:183], v[120:135]
    s_waitcnt vmcnt(1)
    s_barrier
    ds_read_b128 v[136:139], v2 offset:49152
    v_cvt_pk_bf16_f32 v184, v88, v89
    v_cvt_pk_bf16_f32 v185, v90, v91
    v_cvt_pk_bf16_f32 v186, v92, v93
    v_cvt_pk_bf16_f32 v187, v94, v95
    v_exp_f32 v96, v96
    v_exp_f32 v97, v97
    v_exp_f32 v98, v98
    v_exp_f32 v99, v99
    s_waitcnt lgkmcnt(0)
    v_mfma_f32_32x32x16_bf16 v[72:87], v[136:139], v[16:19], 0
    v_exp_f32 v100, v100
    v_exp_f32 v101, v101
    v_exp_f32 v102, v102
    v_exp_f32 v103, v103
    v_cvt_pk_bf16_f32 v188, v96, v97
    v_cvt_pk_bf16_f32 v189, v98, v99
    v_cvt_pk_bf16_f32 v190, v100, v101
    v_cvt_pk_bf16_f32 v191, v102, v103
    s_nop 3
    s_setprio 1
    s_waitcnt vmcnt(0)
    v_cmp_ne_u64 vcc, s[48:49], v[8:9]
    s_and_b32 s50, vcc_lo, 12
    s_cselect_b32 s50, s14, 0
    s_cmp_lg_u32 s50, 0
    s_cbranch_scc1 L_c_4
L_c_4r:
    s_lshl_b32 s51, s6, 13
    s_add_u32 m0, s51, 69632
    s_add_u32 s50, s64, 4096
    buffer_load_dwordx4 v12, s[12:15], s50 offen offset:0 sc1 lds
    buffer_load_dwordx4 v12, s[12:15], s50 offen offset:1024 sc1 lds
    buffer_load_dwordx4 v12, s[12:15], s50 offen offset:2048 sc1 lds
    buffer_load_dwordx4 v12, s[12:15], s50 offen offset:3072 sc1 lds
    ds_read_b128 v[140:143], v2 offset:40960
    v_exp_f32 v72, v72
    v_exp_f32 v73, v73
    v_exp_f32 v74, v74
    v_exp_f32 v75, v75
    s_waitcnt lgkmcnt(1)
    v_mfma_f32_32x32x16_bf16 v[104:119], v[152:155], v[184:187], 0
    v_exp_f32 v76, v76
    v_exp_f32 v77, v77
    v_exp_f32 v78, v78
    v_exp_f32 v79, v79
    s_waitcnt lgkmcnt(0)
    v_mfma_f32_32x32x16_bf16 v[88:103], v[140:143], v[16:19], 0
    v_cvt_pk_bf16_f32 v192, v72, v73
    v_cvt_pk_bf16_f32 v193, v74, v75
    v_cvt_pk_bf16_f32 v194, v76, v77
    v_cvt_pk_bf16_f32 v195, v78, v79
    v_exp_f32 v80, v80
    v_exp_f32 v81, v81
    v_exp_f32 v82, v82
    v_exp_f32 v83, v83
    v_mfma_f32_32x32x16_bf16 v[104:119], v[156:159], v[188:191], v[104:119]
    v_exp_f32 v84, v84
    v_exp_f32 v85, v85
    v_exp_f32 v86, v86
    v_exp_f32 v87, v87
    v_cvt_pk_bf16_f32 v196, v80, v81
    v_cvt_pk_bf16_f32 v197, v82, v83
    v_cvt_pk_bf16_f32 v198, v84, v85
    v_cvt_pk_bf16_f32 v199, v86, v87
    s_setprio 0
    s_cmp_le_u32 1, s59
    s_cselect_b64 s[32:33], s[60:61], -1
    s_cmp_le_u32 2, s59
    s_cselect_b64 s[34:35], s[60:61], -1
    s_cmp_le_u32 3, s59
    s_cselect_b64 s[36:37], s[60:61], -1
    s_cmp_le_u32 4, s59
    s_cselect_b64 s[38:39], s[60:61], -1
    s_cmp_le_u32 5, s59
    s_cselect_b64 s[40:41], s[60:61], -1
    s_cmp_le_u32 6, s59
    s_cselect_b64 s[42:43], s[60:61], -1
    s_cmp_le_u32 7, s59
    s_cselect_b64 s[44:45], s[60:61], -1
    s_cmp_le_u32 8, s59
    s_cselect_b64 s[46:47], s[60:61], -1
    ds_read_b128 v[136:139], v2 offset:32768
    v_exp_f32 v88, v88
    v_exp_f32 v89, v89
    v_exp_f32 v90, v90
    v_exp_f32 v91, v91
    v_exp_f32 v92, v92
    v_exp_f32 v93, v93
    v_exp_f32 v94, v94
    v_exp_f32 v95, v95
    s_waitcnt lgkmcnt(0)
    v_mfma_f32_32x32x16_bf16 v[72:87], v[136:139], v[16:19], 0
    v_cvt_pk_bf16_f32 v200, v88, v89
    v_cvt_pk_bf16_f32 v201, v90, v91
    v_cvt_pk_bf16_f32 v202, v92, v93
    v_cvt_pk_bf16_f32 v203, v94, v95
    v_exp_f32 v96, v96
    v_exp_f32 v97, v97
    v_exp_f32 v98, v98
    v_exp_f32 v99, v99
    v_exp_f32 v100, v100
    v_exp_f32 v101, v101
    v_exp_f32 v102, v102
    v_exp_f32 v103, v103
    v_cvt_pk_bf16_f32 v204, v96, v97
    v_cvt_pk_bf16_f32 v205, v98, v99
    v_cvt_pk_bf16_f32 v206, v100, v101
    v_cvt_pk_bf16_f32 v207, v102, v103
    v_bfe_u32 v4, v1, 2, 3
    s_lshl_b32 s50, s6, 3
    v_add_u32 v4, s50, v4
    v_lshlrev_b32 v4, 10, v4
    v_lshrrev_b32 v5, 5, v1
    v_lshl_add_u32 v4, v5, 6, v4
    v_and_b32 v5, 3, v1
    v_lshl_add_u32 v4, v5, 4, v4
    v_and_b32 v5, 16, v1
    v_lshlrev_b32 v5, 1, v5
    v_xor_b32 v4, v5, v4
    s_and_b32 s50, s54, 7
    s_lshl_b32 s50, s50, 7
    v_add_u32 v4, s50, v4
    v_mov_b32 v168, v11
    v_mov_b32 v169, v11
    v_mov_b32 v170, v11
    v_mov_b32 v171, v11
    v_mov_b32 v172, v11
    v_mov_b32 v173, v11
    v_mov_b32 v174, v11
    v_mov_b32 v175, v11
    ds_read_b128 v[140:143], v2 offset:24576
    v_exp_f32 v72, v72
    v_exp_f32 v73, v73
    v_exp_f32 v74, v74
    v_exp_f32 v75, v75
    v_exp_f32 v76, v76
    v_exp_f32 v77, v77
    v_exp_f32 v78, v78
    v_exp_f32 v79, v79
    s_waitcnt lgkmcnt(0)
    v_mfma_f32_32x32x16_bf16 v[88:103], v[140:143], v[16:19], 0
    v_cvt_pk_bf16_f32 v208, v72, v73
    v_cvt_pk_bf16_f32 v209, v74, v75
    v_cvt_pk_bf16_f32 v210, v76, v77
    v_cvt_pk_bf16_f32 v211, v78, v79
    v_exp_f32 v80, v80
    v_exp_f32 v81, v81
    v_exp_f32 v82, v82
    v_exp_f32 v83, v83
    v_exp_f32 v84, v84
    v_exp_f32 v85, v85
    v_exp_f32 v86, v86
    v_exp_f32 v87, v87
    v_cvt_pk_bf16_f32 v212, v80, v81
    v_cvt_pk_bf16_f32 v213, v82, v83
    v_cvt_pk_bf16_f32 v214, v84, v85
    v_cvt_pk_bf16_f32 v215, v86, v87
    s_setprio 3
    s_waitcnt vmcnt(0)
    s_barrier
    s_and_b32 s50, s54, 15
    s_lshl_b32 s50, s50, 3
    s_add_u32 s50, s50, s6
    s_lshl_b32 s50, s50, 12
    v_lshlrev_b32 v38, 7, v1
    s_mov_b32 exec_hi, 0
    buffer_load_dword v39, v38, s[16:19], s50 offen
    s_mov_b32 exec_hi, -1
    s_mov_b64 s[28:29], s[70:71]
    s_mov_b32 s30, 524288
    s_and_b32 s50, s54, 15
    s_lshl_b32 s50, s50, 3
    s_add_u32 s50, s50, s6
    s_lshl_b32 s50, s50, 12
    v_lshlrev_b32 v36, 7, v1
    s_mov_b32 exec_hi, 0
    buffer_load_dword v37, v36, s[28:31], s50 offen
    s_mov_b32 exec_hi, -1
    ds_read_b128 v[136:139], v2 offset:16384
    s_mov_b64 exec, s[32:33]
    ds_read_b128 v[160:163], v3 offset:49152
    ds_read_b128 v[164:167], v3 offset:50176
    s_mov_b64 exec, s[34:35]
    ds_read_b128 v[168:171], v3 offset:40960
    ds_read_b128 v[172:175], v3 offset:41984
    s_mov_b64 exec, -1
    v_exp_f32 v88, v88
    v_exp_f32 v89, v89
    v_exp_f32 v90, v90
    v_exp_f32 v91, v91
    v_exp_f32 v92, v92
    v_exp_f32 v93, v93
    v_exp_f32 v94, v94
    v_exp_f32 v95, v95
    s_waitcnt lgkmcnt(4)
    v_mfma_f32_32x32x16_bf16 v[72:87], v[136:139], v[16:19], 0
    v_cvt_pk_bf16_f32 v216, v88, v89
    v_cvt_pk_bf16_f32 v217, v90, v91
    v_cvt_pk_bf16_f32 v218, v92, v93
    v_cvt_pk_bf16_f32 v219, v94, v95
    v_exp_f32 v96, v96
    v_exp_f32 v97, v97
    v_exp_f32 v98, v98
    v_exp_f32 v99, v99
    v_exp_f32 v100, v100
    v_exp_f32 v101, v101
    v_exp_f32 v102, v102
    v_exp_f32 v103, v103
    v_cvt_pk_bf16_f32 v220, v96, v97
    v_cvt_pk_bf16_f32 v221, v98, v99
    v_cvt_pk_bf16_f32 v222, v100, v101
    v_cvt_pk_bf16_f32 v223, v102, v103
    ds_read_b128 v[140:143], v2 offset:8192
    s_mov_b64 exec, s[36:37]
    ds_read_b128 v[144:147], v3 offset:32768
    ds_read_b128 v[148:151], v3 offset:33792
    s_mov_b64 exec, s[38:39]
    ds_read_b128 v[152:155], v3 offset:24576
    ds_read_b128 v[156:159], v3 offset:25600
    s_mov_b64 exec, -1
    v_exp_f32 v72, v72
    v_exp_f32 v73, v73
    v_exp_f32 v74, v74
    v_exp_f32 v75, v75
    s_waitcnt lgkmcnt(5)
    v_mfma_f32_32x32x16_bf16 v[104:119], v[160:163], v[192:195], v[104:119]
    v_exp_f32 v76, v76
    v_exp_f32 v77, v77
    v_exp_f32 v78, v78
    v_exp_f32 v79, v79
    s_waitcnt lgkmcnt(4)
    v_mfma_f32_32x32x16_bf16 v[88:103], v[140:143], v[16:19], 0
    v_cvt_pk_bf16_f32 v224, v72, v73
    v_cvt_pk_bf16_f32 v225, v74, v75
    v_cvt_pk_bf16_f32 v226, v76, v77
    v_cvt_pk_bf16_f32 v227, v78, v79
    v_exp_f32 v80, v80
    v_exp_f32 v81, v81
    v_mfma_f32_32x32x16_bf16 v[104:119], v[164:167], v[196:199], v[104:119]
    v_exp_f32 v82, v82
    v_exp_f32 v83, v83
    v_exp_f32 v84, v84
    v_exp_f32 v85, v85
    v_mfma_f32_32x32x16_bf16 v[104:119], v[168:171], v[200:203], v[104:119]
    v_exp_f32 v86, v86
    v_exp_f32 v87, v87
    v_cvt_pk_bf16_f32 v228, v80, v81
    v_cvt_pk_bf16_f32 v229, v82, v83
    v_cvt_pk_bf16_f32 v230, v84, v85
    v_cvt_pk_bf16_f32 v231, v86, v87
    v_mfma_f32_32x32x16_bf16 v[104:119], v[172:175], v[204:207], v[104:119]
    ds_read_b128 v[136:139], v2 offset:0
    s_mov_b64 exec, s[40:41]
    ds_read_b128 v[160:163], v3 offset:16384
    ds_read_b128 v[164:167], v3 offset:17408
    s_mov_b64 exec, s[42:43]
    ds_read_b128 v[168:171], v3 offset:8192
    ds_read_b128 v[172:175], v3 offset:9216
    s_mov_b64 exec, -1
    v_exp_f32 v88, v88
    v_exp_f32 v89, v89
    v_exp_f32 v90, v90
    v_exp_f32 v91, v91
    s_waitcnt lgkmcnt(5)
    v_mfma_f32_32x32x16_bf16 v[104:119], v[144:147], v[208:211], v[104:119]
    v_exp_f32 v92, v92
    v_exp_f32 v93, v93
    v_exp_f32 v94, v94
    v_exp_f32 v95, v95
    s_waitcnt lgkmcnt(4)
    v_mfma_f32_32x32x16_bf16 v[72:87], v[136:139], v[16:19], 0
    v_cvt_pk_bf16_f32 v232, v88, v89
    v_cvt_pk_bf16_f32 v233, v90, v91
    v_cvt_pk_bf16_f32 v234, v92, v93
    v_cvt_pk_bf16_f32 v235, v94, v95
    v_exp_f32 v96, v96
    v_exp_f32 v97, v97
    v_mfma_f32_32x32x16_bf16 v[104:119], v[148:151], v[212:215], v[104:119]
    v_exp_f32 v98, v98
    v_exp_f32 v99, v99
    v_exp_f32 v100, v100
    v_exp_f32 v101, v101
    v_mfma_f32_32x32x16_bf16 v[104:119], v[152:155], v[216:219], v[104:119]
    v_exp_f32 v102, v102
    v_exp_f32 v103, v103
    v_cvt_pk_bf16_f32 v236, v96, v97
    v_cvt_pk_bf16_f32 v237, v98, v99
    v_cvt_pk_bf16_f32 v238, v100, v101
    v_cvt_pk_bf16_f32 v239, v102, v103
    v_mfma_f32_32x32x16_bf16 v[104:119], v[156:159], v[220:223], v[104:119]
    ds_read_b128 v[140:143], v0 offset:0
    s_mov_b64 exec, s[44:45]
    ds_read_b128 v[144:147], v3 offset:0
    ds_read_b128 v[148:151], v3 offset:1024
    s_mov_b64 exec, -1
    v_exp_f32 v72, v72
    v_exp_f32 v73, v73
    v_exp_f32 v74, v74
    v_exp_f32 v75, v75
    s_waitcnt lgkmcnt(3)
    v_mfma_f32_32x32x16_bf16 v[104:119], v[160:163], v[224:227], v[104:119]
    v_exp_f32 v76, v76
    v_exp_f32 v77, v77
    v_exp_f32 v78, v78
    v_exp_f32 v79, v79
    s_waitcnt lgkmcnt(2)
    v_mfma_f32_32x32x16_bf16 v[88:103], v[140:143], v[16:19], v[56:71]
    v_cvt_pk_bf16_f32 v176, v72, v73
    v_cvt_pk_bf16_f32 v177, v74, v75
    v_cvt_pk_bf16_f32 v178, v76, v77
    v_cvt_pk_bf16_f32 v179, v78, v79
    v_exp_f32 v80, v80
    v_exp_f32 v81, v81
    v_mfma_f32_32x32x16_bf16 v[104:119], v[164:167], v[228:231], v[104:119]
    v_exp_f32 v82, v82
    v_exp_f32 v83, v83
    v_exp_f32 v84, v84
    v_exp_f32 v85, v85
    v_mfma_f32_32x32x16_bf16 v[104:119], v[168:171], v[232:235], v[104:119]
    v_exp_f32 v86, v86
    v_exp_f32 v87, v87
    v_cvt_pk_bf16_f32 v180, v80, v81
    v_cvt_pk_bf16_f32 v181, v82, v83
    v_cvt_pk_bf16_f32 v182, v84, v85
    v_cvt_pk_bf16_f32 v183, v86, v87
    v_mfma_f32_32x32x16_bf16 v[104:119], v[172:175], v[236:239], v[104:119]
    s_setprio 2
    ds_read_b128 v[136:139], v2 offset:50176
    s_mov_b64 exec, s[46:47]
    ds_read_b128 v[152:155], v7 offset:0
    ds_read_b128 v[156:159], v7 offset:1024
    s_mov_b64 exec, -1
    v_exp_f32 v88, v88
    v_exp_f32 v89, v89
    v_exp_f32 v90, v90
    v_exp_f32 v91, v91
    s_waitcnt lgkmcnt(3)
    v_mfma_f32_32x32x16_bf16 v[104:119], v[144:147], v[176:179], v[104:119]
    v_exp_f32 v92, v92
    v_exp_f32 v93, v93
    v_exp_f32 v94, v94
    v_exp_f32 v95, v95
    s_waitcnt lgkmcnt(2)
    v_mfma_f32_32x32x16_bf16 v[72:87], v[136:139], v[20:23], 0
    v_cvt_pk_bf16_f32 v184, v88, v89
    v_cvt_pk_bf16_f32 v185, v90, v91
    v_cvt_pk_bf16_f32 v186, v92, v93
    v_cvt_pk_bf16_f32 v187, v94, v95
    v_exp_f32 v96, v96
    v_exp_f32 v97, v97
    v_exp_f32 v98, v98
    v_exp_f32 v99, v99
    v_mfma_f32_32x32x16_bf16 v[104:119], v[148:151], v[180:183], v[104:119]
    v_exp_f32 v100, v100
    v_exp_f32 v101, v101
    v_exp_f32 v102, v102
    v_exp_f32 v103, v103
    v_cvt_pk_bf16_f32 v188, v96, v97
    v_cvt_pk_bf16_f32 v189, v98, v99
    v_cvt_pk_bf16_f32 v190, v100, v101
    v_cvt_pk_bf16_f32 v191, v102, v103
    s_cmp_lt_u32 s59, 8
    s_cbranch_scc1 L_c_5
L_c_5r:
    ds_read_b128 v[140:143], v2 offset:41984
    s_mov_b64 exec, s[32:33]
    ds_read_b128 v[160:163], v3 offset:49408
    ds_read_b128 v[164:167], v3 offset:50432
    s_mov_b64 exec, -1
    v_exp_f32 v72, v72
    v_exp_f32 v73, v73
    v_exp_f32 v74, v74
    v_exp_f32 v75, v75
    s_waitcnt lgkmcnt(3)
    v_mfma_f32_32x32x16_bf16 v[104:119], v[152:155], v[184:187], v[104:119]
    v_exp_f32 v76, v76
    v_exp_f32 v77, v77
    v_exp_f32 v78, v78
    v_exp_f32 v79, v79
    s_waitcnt lgkmcnt(2)
    v_mfma_f32_32x32x16_bf16 v[88:103], v[140:143], v[20:23], 0
    v_cvt_pk_bf16_f32 v192, v72, v73
    v_cvt_pk_bf16_f32 v193, v74, v75
    v_cvt_pk_bf16_f32 v194, v76, v77
    v_cvt_pk_bf16_f32 v195, v78, v79
    v_exp_f32 v80, v80
    v_exp_f32 v81, v81
    v_exp_f32 v82, v82
    v_exp_f32 v83, v83
    v_mfma_f32_32x32x16_bf16 v[104:119], v[156:159], v[188:191], v[104:119]
    v_exp_f32 v84, v84
    v_exp_f32 v85, v85
    v_exp_f32 v86, v86
    v_exp_f32 v87, v87
    v_cvt_pk_bf16_f32 v196, v80, v81
    v_cvt_pk_bf16_f32 v197, v82, v83
    v_cvt_pk_bf16_f32 v198, v84, v85
    v_cvt_pk_bf16_f32 v199, v86, v87
    s_cmp_lt_u32 s59, 8
    s_cbranch_scc1 L_c_6
L_c_6r:
    ds_read_b128 v[136:139], v2 offset:33792
    s_mov_b64 exec, s[34:35]
    ds_read_b128 v[168:171], v3 offset:41216
    ds_read_b128 v[172:175], v3 offset:42240
    s_mov_b64 exec, -1
    v_exp_f32 v88, v88
    v_exp_f32 v89, v89
    v_exp_f32 v90, v90
    v_exp_f32 v91, v91
    s_waitcnt lgkmcnt(3)
    v_mfma_f32_32x32x16_bf16 v[120:135], v[160:163], v[192:195], v[120:135]
    v_exp_f32 v92, v92
    v_exp_f32 v93, v93
    v_exp_f32 v94, v94
    v_exp_f32 v95, v95
    s_waitcnt lgkmcnt(2)
    v_mfma_f32_32x32x16_bf16 v[72:87], v[136:139], v[20:23], 0
    v_cvt_pk_bf16_f32 v200, v88, v89
    v_cvt_pk_bf16_f32 v201, v90, v91
    v_cvt_pk_bf16_f32 v202, v92, v93
    v_cvt_pk_bf16_f32 v203, v94, v95
    v_exp_f32 v96, v96
    v_exp_f32 v97, v97
    v_exp_f32 v98, v98
    v_exp_f32 v99, v99
    v_mfma_f32_32x32x16_bf16 v[120:135], v[164:167], v[196:199], v[120:135]
    v_exp_f32 v100, v100
    v_exp_f32 v101, v101
    v_exp_f32 v102, v102
    v_exp_f32 v103, v103
    v_cvt_pk_bf16_f32 v204, v96, v97
    v_cvt_pk_bf16_f32 v205, v98, v99
    v_cvt_pk_bf16_f32 v206, v100, v101
    v_cvt_pk_bf16_f32 v207, v102, v103
    v_rcp_f32 v114, v112
    v_pk_add_f32 v[116:117], v[104:105], v[106:107]
    v_pk_add_f32 v[118:119], v[108:109], v[110:111]
    v_pk_mul_f32 v[104:105], v[104:105], v[114:115] op_sel_hi:[1,0]
    v_pk_mul_f32 v[106:107], v[106:107], v[114:115] op_sel_hi:[1,0]
    v_pk_mul_f32 v[108:109], v[108:109], v[114:115] op_sel_hi:[1,0]
    v_pk_mul_f32 v[110:111], v[110:111], v[114:115] op_sel_hi:[1,0]
    v_pk_add_f32 v[116:117], v[116:117], v[118:119]
    v_cvt_pk_bf16_f32 v24, v104, v105
    v_cvt_pk_bf16_f32 v25, v106, v107
    v_cvt_pk_bf16_f32 v26, v108, v109
    v_cvt_pk_bf16_f32 v27, v110, v111
    v_add_f32 v116, v116, v117
    v_fma_f32 v112, v116, 0, v112
    v_subrev_u32 v112, 0x2b800000, v112
    v_cmp_lt_u32 vcc, 0x28000000, v112
    s_or_b32 s67, vcc_lo, vcc_hi
    buffer_store_dwordx4 v[24:27], v12, s[24:27], s68 offen sc1
    s_setprio 1
    s_cmp_lt_u32 s59, 8
    s_cbranch_scc1 L_c_7
L_c_7r:
    ds_read_b128 v[140:143], v2 offset:25600
    s_mov_b64 exec, s[36:37]
    ds_read_b128 v[144:147], v3 offset:33024
    ds_read_b128 v[148:151], v3 offset:34048
    s_mov_b64 exec, -1
    v_exp_f32 v72, v72
    v_exp_f32 v73, v73
    v_exp_f32 v74, v74
    v_exp_f32 v75, v75
    s_waitcnt lgkmcnt(3)
    v_mfma_f32_32x32x16_bf16 v[120:135], v[168:171], v[200:203], v[120:135]
    v_exp_f32 v76, v76
    v_exp_f32 v77, v77
    v_exp_f32 v78, v78
    v_exp_f32 v79, v79
    s_waitcnt lgkmcnt(2)
    v_mfma_f32_32x32x16_bf16 v[88:103], v[140:143], v[20:23], 0
    v_cvt_pk_bf16_f32 v208, v72, v73
    v_cvt_pk_bf16_f32 v209, v74, v75
    v_cvt_pk_bf16_f32 v210, v76, v77
    v_cvt_pk_bf16_f32 v211, v78, v79
    v_exp_f32 v80, v80
    v_exp_f32 v81, v81
    v_exp_f32 v82, v82
    v_exp_f32 v83, v83
    v_mfma_f32_32x32x16_bf16 v[120:135], v[172:175], v[204:207], v[120:135]
    v_exp_f32 v84, v84
    v_exp_f32 v85, v85
    v_exp_f32 v86, v86
    v_exp_f32 v87, v87
    v_cvt_pk_bf16_f32 v212, v80, v81
    v_cvt_pk_bf16_f32 v213, v82, v83
    v_cvt_pk_bf16_f32 v214, v84, v85
    v_cvt_pk_bf16_f32 v215, v86, v87
    s_waitcnt vmcnt(0)
    s_cmp_lg_u32 s67, 0
    s_cbranch_scc1 L_noflag0
    s_mov_b64 exec, 0xffff
    buffer_store_dwordx2 v[14:15], v13, s[24:27], s69 offen sc1
    s_mov_b64 exec, -1
L_noflag0:
    s_add_u32 m0, s7, 0
    s_mov_b32 s50, 0
    buffer_load_dwordx4 v4, s[16:19], s50 offen lds
    s_add_u32 m0, s7, 8192
    s_mov_b32 s50, 65536
    buffer_load_dwordx4 v4, s[16:19], s50 offen lds
    s_cmp_lt_u32 s59, 8
    s_cbranch_scc1 L_c_8
L_c_8r:
    ds_read_b128 v[136:139], v2 offset:17408
    s_mov_b64 exec, s[38:39]
    ds_read_b128 v[152:155], v3 offset:24832
    ds_read_b128 v[156:159], v3 offset:25856
    s_mov_b64 exec, -1
    v_exp_f32 v88, v88
    v_exp_f32 v89, v89
    v_exp_f32 v90, v90
    v_exp_f32 v91, v91
    s_waitcnt lgkmcnt(3)
    v_mfma_f32_32x32x16_bf16 v[120:135], v[144:147], v[208:211], v[120:135]
    v_exp_f32 v92, v92
    v_exp_f32 v93, v93
    v_exp_f32 v94, v94
    v_exp_f32 v95, v95
    s_waitcnt lgkmcnt(2)
    v_mfma_f32_32x32x16_bf16 v[72:87], v[136:139], v[20:23], 0
    v_cvt_pk_bf16_f32 v216, v88, v89
    v_cvt_pk_bf16_f32 v217, v90, v91
    v_cvt_pk_bf16_f32 v218, v92, v93
    v_cvt_pk_bf16_f32 v219, v94, v95
    v_exp_f32 v96, v96
    v_exp_f32 v97, v97
    v_exp_f32 v98, v98
    v_exp_f32 v99, v99
    v_mfma_f32_32x32x16_bf16 v[120:135], v[148:151], v[212:215], v[120:135]
    v_exp_f32 v100, v100
    v_exp_f32 v101, v101
    v_exp_f32 v102, v102
    v_exp_f32 v103, v103
    v_cvt_pk_bf16_f32 v220, v96, v97
    v_cvt_pk_bf16_f32 v221, v98, v99
    v_cvt_pk_bf16_f32 v222, v100, v101
    v_cvt_pk_bf16_f32 v223, v102, v103
    s_add_u32 m0, s7, 16384
    s_mov_b32 s50, 131072
    buffer_load_dwordx4 v4, s[16:19], s50 offen lds
    s_add_u32 m0, s7, 24576
    s_mov_b32 s50, 196608
    buffer_load_dwordx4 v4, s[16:19], s50 offen lds
    ds_read_b128 v[140:143], v2 offset:9216
    s_mov_b64 exec, s[40:41]
    ds_read_b128 v[160:163], v3 offset:16640
    ds_read_b128 v[164:167], v3 offset:17664
    s_mov_b64 exec, -1
    v_exp_f32 v72, v72
    v_exp_f32 v73, v73
    v_exp_f32 v74, v74
    v_exp_f32 v75, v75
    s_waitcnt lgkmcnt(3)
    v_mfma_f32_32x32x16_bf16 v[120:135], v[152:155], v[216:219], v[120:135]
    v_exp_f32 v76, v76
    v_exp_f32 v77, v77
    v_exp_f32 v78, v78
    v_exp_f32 v79, v79
    s_waitcnt lgkmcnt(2)
    v_mfma_f32_32x32x16_bf16 v[88:103], v[140:143], v[20:23], 0
    v_cvt_pk_bf16_f32 v224, v72, v73
    v_cvt_pk_bf16_f32 v225, v74, v75
    v_cvt_pk_bf16_f32 v226, v76, v77
    v_cvt_pk_bf16_f32 v227, v78, v79
    v_exp_f32 v80, v80
    v_exp_f32 v81, v81
    v_exp_f32 v82, v82
    v_exp_f32 v83, v83
    v_mfma_f32_32x32x16_bf16 v[120:135], v[156:159], v[220:223], v[120:135]
    v_exp_f32 v84, v84
    v_exp_f32 v85, v85
    v_exp_f32 v86, v86
    v_exp_f32 v87, v87
    v_cvt_pk_bf16_f32 v228, v80, v81
    v_cvt_pk_bf16_f32 v229, v82, v83
    v_cvt_pk_bf16_f32 v230, v84, v85
    v_cvt_pk_bf16_f32 v231, v86, v87
    s_add_u32 m0, s7, 32768
    s_mov_b32 s50, 262144
    buffer_load_dwordx4 v4, s[16:19], s50 offen lds
    s_add_u32 m0, s7, 40960
    s_mov_b32 s50, 327680
    buffer_load_dwordx4 v4, s[16:19], s50 offen lds
    ds_read_b128 v[136:139], v2 offset:1024
    s_mov_b64 exec, s[42:43]
    ds_read_b128 v[168:171], v3 offset:8448
    ds_read_b128 v[172:175], v3 offset:9472
    s_mov_b64 exec, -1
    v_exp_f32 v88, v88
    v_exp_f32 v89, v89
    v_exp_f32 v90, v90
    v_exp_f32 v91, v91
    s_waitcnt lgkmcnt(3)
    v_mfma_f32_32x32x16_bf16 v[120:135], v[160:163], v[224:227], v[120:135]
    v_exp_f32 v92, v92
    v_exp_f32 v93, v93
    v_exp_f32 v94, v94
    v_exp_f32 v95, v95
    s_waitcnt lgkmcnt(2)
    v_mfma_f32_32x32x16_bf16 v[72:87], v[136:139], v[20:23], 0
    v_cvt_pk_bf16_f32 v232, v88, v89
    v_cvt_pk_bf16_f32 v233, v90, v91
    v_cvt_pk_bf16_f32 v234, v92, v93
    v_cvt_pk_bf16_f32 v235, v94, v95
    v_exp_f32 v96, v96
    v_exp_f32 v97, v97
    v_exp_f32 v98, v98
    v_exp_f32 v99, v99
    v_mfma_f32_32x32x16_bf16 v[120:135], v[164:167], v[228:231], v[120:135]
    v_exp_f32 v100, v100
    v_exp_f32 v101, v101
    v_exp_f32 v102, v102
    v_exp_f32 v103, v103
    v_cvt_pk_bf16_f32 v236, v96, v97
    v_cvt_pk_bf16_f32 v237, v98, v99
    v_cvt_pk_bf16_f32 v238, v100, v101
    v_cvt_pk_bf16_f32 v239, v102, v103
    s_setprio 0
    s_add_u32 m0, s7, 49152
    s_mov_b32 s50, 393216
    buffer_load_dwordx4 v4, s[16:19], s50 offen lds
    s_add_u32 m0, s7, 57344
    s_mov_b32 s50, 458752
    buffer_load_dwordx4 v4, s[16:19], s50 offen lds
    ds_read_b128 v[140:143], v0 offset:1024
    s_mov_b64 exec, s[44:45]
    ds_read_b128 v[144:147], v3 offset:256
    ds_read_b128 v[148:151], v3 offset:1280
    s_mov_b64 exec, -1
    v_exp_f32 v72, v72
    v_exp_f32 v73, v73
    v_exp_f32 v74, v74
    v_exp_f32 v75, v75
    s_waitcnt lgkmcnt(3)
    v_mfma_f32_32x32x16_bf16 v[120:135], v[168:171], v[232:235], v[120:135]
    v_exp_f32 v76, v76
    v_exp_f32 v77, v77
    v_exp_f32 v78, v78
    v_exp_f32 v79, v79
    s_waitcnt lgkmcnt(2)
    v_mfma_f32_32x32x16_bf16 v[88:103], v[140:143], v[20:23], v[56:71]
    v_cvt_pk_bf16_f32 v176, v72, v73
    v_cvt_pk_bf16_f32 v177, v74, v75
    v_cvt_pk_bf16_f32 v178, v76, v77
    v_cvt_pk_bf16_f32 v179, v78, v79
    v_exp_f32 v80, v80
    v_exp_f32 v81, v81
    v_exp_f32 v82, v82
    v_exp_f32 v83, v83
    v_mfma_f32_32x32x16_bf16 v[120:135], v[172:175], v[236:239], v[120:135]
    v_exp_f32 v84, v84
    v_exp_f32 v85, v85
    v_exp_f32 v86, v86
    v_exp_f32 v87, v87
    v_cvt_pk_bf16_f32 v180, v80, v81
    v_cvt_pk_bf16_f32 v181, v82, v83
    v_cvt_pk_bf16_f32 v182, v84, v85
    v_cvt_pk_bf16_f32 v183, v86, v87
    s_cmp_lt_u32 s6, 4
    s_cbranch_scc1 L_c_9
L_c_9r:
    s_mov_b64 exec, s[46:47]
    ds_read_b128 v[152:155], v7 offset:256
    ds_read_b128 v[156:159], v7 offset:1280
    s_mov_b64 exec, -1
    v_exp_f32 v88, v88
    v_exp_f32 v89, v89
    v_exp_f32 v90, v90
    v_exp_f32 v91, v91
    s_waitcnt lgkmcnt(2)
    v_mfma_f32_32x32x16_bf16 v[120:135], v[144:147], v[176:179], v[120:135]
    v_exp_f32 v92, v92
    v_exp_f32 v93, v93
    v_exp_f32 v94, v94
    v_exp_f32 v95, v95
    v_cvt_pk_bf16_f32 v184, v88, v89
    v_cvt_pk_bf16_f32 v185, v90, v91
    v_cvt_pk_bf16_f32 v186, v92, v93
    v_cvt_pk_bf16_f32 v187, v94, v95
    v_exp_f32 v96, v96
    v_exp_f32 v97, v97
    v_exp_f32 v98, v98
    v_exp_f32 v99, v99
    v_mfma_f32_32x32x16_bf16 v[120:135], v[148:151], v[180:183], v[120:135]
    v_exp_f32 v100, v100
    v_exp_f32 v101, v101
    v_exp_f32 v102, v102
    v_exp_f32 v103, v103
    v_cvt_pk_bf16_f32 v188, v96, v97
    v_cvt_pk_bf16_f32 v189, v98, v99
    v_cvt_pk_bf16_f32 v190, v100, v101
    v_cvt_pk_bf16_f32 v191, v102, v103
    s_waitcnt lgkmcnt(0)
    s_nop 0
    v_mfma_f32_32x32x16_bf16 v[120:135], v[152:155], v[184:187], v[120:135]
    v_mfma_f32_32x32x16_bf16 v[120:135], v[156:159], v[188:191], v[120:135]
    s_nop 11
    v_rcp_f32 v130, v128
    v_pk_add_f32 v[132:133], v[120:121], v[122:123]
    v_pk_add_f32 v[134:135], v[124:125], v[126:127]
    v_pk_mul_f32 v[120:121], v[120:121], v[130:131] op_sel_hi:[1,0]
    v_pk_mul_f32 v[122:123], v[122:123], v[130:131] op_sel_hi:[1,0]
    v_pk_mul_f32 v[124:125], v[124:125], v[130:131] op_sel_hi:[1,0]
    v_pk_mul_f32 v[126:127], v[126:127], v[130:131] op_sel_hi:[1,0]
    v_pk_add_f32 v[132:133], v[132:133], v[134:135]
    v_cvt_pk_bf16_f32 v28, v120, v121
    v_cvt_pk_bf16_f32 v29, v122, v123
    v_cvt_pk_bf16_f32 v30, v124, v125
    v_cvt_pk_bf16_f32 v31, v126, v127
    v_add_f32 v132, v132, v133
    v_fma_f32 v128, v132, 0, v128
    v_subrev_u32 v128, 0x2b800000, v128
    v_cmp_lt_u32 vcc, 0x28000000, v128
    s_cbranch_vccnz L_B_slow1
L_B_ok1:
    s_setprio 2
    buffer_store_dwordx4 v[28:31], v12, s[24:27], s68 offen offset:1024 sc1
    s_setprio 0
    s_cmp_lg_u32 s67, 0
    s_cbranch_scc1 L_B_slow0
L_B_ok0:
    s_cmp_lt_u32 s6, 4
    s_cbranch_scc0 L_young
    s_mov_b32 s67, 0
    s_lshl_b32 s50, s3, 6
    s_add_u32 s50, s50, s55
    s_lshl_b32 s64, s50, 15
    s_add_u32 s64, s64, 8388608
    s_lshl_b32 s65, s50, 12
    s_add_u32 s65, s65, 13107200
    v_lshlrev_b32 v10, 7, v1
    s_brev_b32 s36, s67
    s_lshr_b32 s36, s36, 20
    s_add_u32 s32, s36, s64
    s_add_u32 s67, s67, 1
    s_and_b32 s67, s67, 3
    s_brev_b32 s36, s67
    s_lshr_b32 s36, s36, 20
    s_add_u32 s33, s36, s64
    s_add_u32 s67, s67, 1
    s_and_b32 s67, s67, 3
    s_brev_b32 s36, s67
    s_lshr_b32 s36, s36, 20
    s_add_u32 s34, s36, s64
    s_add_u32 s67, s67, 1
    s_and_b32 s67, s67, 3
    s_brev_b32 s36, s67
    s_lshr_b32 s36, s36, 20
    s_add_u32 s35, s36, s64
    s_add_u32 s67, s67, 1
    s_and_b32 s67, s67, 3
    v_and_b32 v5, 0xf0, v12
    v_bfe_u32 v36, v1, 4, 1
    v_lshl_add_u32 v5, v36, 9, v5
    v_lshrrev_b32 v36, 5, v1
    v_lshl_add_u32 v5, v36, 12, v5
    s_and_b32 s50, s54, 1
    s_lshl_b32 s50, s50, 11
    s_xor_b32 s32, s32, s50
    s_xor_b32 s33, s33, s50
    s_xor_b32 s34, s34, s50
    s_xor_b32 s35, s35, s50
    s_waitcnt vmcnt(1)
    s_mov_b64 exec, 0x55555555
    v_cmp_ne_u64 vcc, s[48:49], v[8:9]
    s_mov_b64 exec, -1
    s_mov_b32 s53, 0
    s_mov_b32 s39, vcc_lo
    s_cbranch_vccnz L_p3again
L_p3even:
    buffer_load_dwordx4 v[136:139], v5, s[24:27], s32 offen offset:0 sc1
    buffer_load_dwordx4 v[140:143], v5, s[24:27], s32 offen offset:256 sc1
    s_add_u32 s37, s32, 8192
    buffer_load_dwordx4 v[144:147], v5, s[24:27], s37 offen offset:0 sc1
    buffer_load_dwordx4 v[148:151], v5, s[24:27], s37 offen offset:256 sc1
    s_add_u32 s37, s32, 16384
    buffer_load_dwordx4 v[152:155], v5, s[24:27], s37 offen offset:0 sc1
    buffer_load_dwordx4 v[156:159], v5, s[24:27], s37 offen offset:256 sc1
    s_add_u32 s37, s32, 24576
    buffer_load_dwordx4 v[160:163], v5, s[24:27], s37 offen offset:0 sc1
    buffer_load_dwordx4 v[164:167], v5, s[24:27], s37 offen offset:256 sc1
    v_bfe_u32 v36, v1, 2, 2
    v_lshlrev_b32 v2, 6, v36
    v_and_b32 v36, 3, v1
    v_lshl_add_u32 v2, v36, 3, v2
    v_bfe_u32 v36, v1, 4, 1
    v_mul_u32_u24 v36, 288, v36
    v_add_u32 v2, v2, v36
    v_lshrrev_b32 v36, 5, v1
    v_lshl_add_u32 v2, v36, 13, v2
    v_add_u32 v2, s53, v2
    v_xor_b32 v3, 32, v2
    s_and_b32 s50, s32, 0xc00
    s_lshl_b32 s50, s50, 1
    v_add_u32 v0, s50, v2
    v_add_u32 v4, s50, v3
    s_and_b32 s50, s33, 0xc00
    s_lshl_b32 s50, s50, 1
    v_add_u32 v6, s50, v2
    v_add_u32 v16, s50, v3
    s_waitcnt vmcnt(8)
    s_barrier
    s_branch L_p3go
L_p3again:
    s_mov_b32 exec_lo, s39
    s_mov_b32 exec_hi, 0
    buffer_load_dwordx2 v[8:9], v10, s[24:27], s65 offen sc1
    s_mov_b64 exec, -1
    v_bfe_u32 v36, v1, 2, 2
    v_lshlrev_b32 v2, 6, v36
    v_and_b32 v36, 3, v1
    v_lshl_add_u32 v2, v36, 3, v2
    v_bfe_u32 v36, v1, 4, 1
    v_mul_u32_u24 v36, 288, v36
    v_add_u32 v2, v2, v36
    v_lshrrev_b32 v36, 5, v1
    v_lshl_add_u32 v2, v36, 13, v2
    v_add_u32 v2, s53, v2
    v_xor_b32 v3, 32, v2
    s_and_b32 s50, s32, 0xc00
    s_lshl_b32 s50, s50, 1
    v_add_u32 v0, s50, v2
    v_add_u32 v4, s50, v3
    s_and_b32 s50, s33, 0xc00
    s_lshl_b32 s50, s50, 1
    v_add_u32 v6, s50, v2
    v_add_u32 v16, s50, v3
    s_waitcnt vmcnt(1)
    s_barrier
    s_waitcnt vmcnt(0)
    v_cmp_eq_u64 vcc, s[48:49], v[8:9]
    s_andn2_b32 s39, s39, vcc_lo
    s_mov_b32 s58, 0
    s_mov_b32 exec_hi, 0
L_poll_10:
    s_and_b32 s50, s39, 0x55555555
    s_cbranch_scc0 L_poll_10d
    s_and_b32 exec_lo, s39, 0x55555555
    buffer_load_dwordx2 v[8:9], v10, s[24:27], s65 offen sc1
    s_add_u32 s58, s58, 1
    s_waitcnt vmcnt(0)
    v_cmp_eq_u64 vcc, s[48:49], v[8:9]
    s_andn2_b32 s39, s39, vcc_lo
    s_cmp_gt_u32 s58, 400000
    s_cbranch_scc0 L_poll_10
L_poll_10d:
    s_mov_b64 exec, -1
    buffer_load_dwordx4 v[136:139], v5, s[24:27], s32 offen offset:0 sc1
    buffer_load_dwordx4 v[140:143], v5, s[24:27], s32 offen offset:256 sc1
    s_add_u32 s37, s32, 8192
    buffer_load_dwordx4 v[144:147], v5, s[24:27], s37 offen offset:0 sc1
    buffer_load_dwordx4 v[148:151], v5, s[24:27], s37 offen offset:256 sc1
    s_add_u32 s37, s32, 16384
    buffer_load_dwordx4 v[152:155], v5, s[24:27], s37 offen offset:0 sc1
    buffer_load_dwordx4 v[156:159], v5, s[24:27], s37 offen offset:256 sc1
    s_add_u32 s37, s32, 24576
    buffer_load_dwordx4 v[160:163], v5, s[24:27], s37 offen offset:0 sc1
    buffer_load_dwordx4 v[164:167], v5, s[24:27], s37 offen offset:256 sc1
    s_branch L_p3go
L_young:
    s_waitcnt vmcnt(0)
L_youngA:
    s_mov_b64 exec, 0xffff
    s_cmp_eq_u32 s6, 4
    s_cselect_b32 s10, s26, 0
    s_setprio 3
    s_waitcnt vmcnt(8)
    s_barrier
    buffer_store_dwordx2 v[14:15], v13, s[8:11], s69 offen offset:128 sc1
    s_mov_b64 exec, -1
    s_cmp_lg_u32 s6, 4
    s_cbranch_scc1 L_rest
    s_lshl_b32 s50, s3, 6
    s_add_u32 s50, s50, s55
    s_lshl_b32 s64, s50, 15
    s_add_u32 s64, s64, 8388608
    s_lshl_b32 s65, s50, 12
    s_add_u32 s65, s65, 13107200
    v_lshlrev_b32 v10, 7, v1
    s_add_u32 s65, s65, 12288
    s_mov_b32 s52, s48
    s_mov_b32 s53, s48
    s_add_u32 s62, s24, s65
    s_addc_u32 s63, s25, 0
    s_mov_b32 s58, 0
L_sp_11:
    s_load_dword s32, s[62:63], 384 glc
    s_load_dword s33, s[62:63], 896 glc
    s_load_dword s34, s[62:63], 1408 glc
    s_load_dword s35, s[62:63], 1920 glc
    s_load_dword s36, s[62:63], 2432 glc
    s_load_dword s37, s[62:63], 2944 glc
    s_load_dword s38, s[62:63], 3456 glc
    s_load_dword s39, s[62:63], 3968 glc
    s_add_u32 s58, s58, 1
    s_cmp_gt_u32 s58, 400000
    s_waitcnt lgkmcnt(0)
    s_cbranch_scc1 L_sp_11d
    s_xor_b64 s[32:33], s[32:33], s[52:53]
    s_xor_b64 s[34:35], s[34:35], s[52:53]
    s_xor_b64 s[36:37], s[36:37], s[52:53]
    s_xor_b64 s[38:39], s[38:39], s[52:53]
    s_or_b64 s[32:33], s[32:33], s[34:35]
    s_or_b64 s[32:33], s[32:33], s[36:37]
    s_or_b64 s[32:33], s[32:33], s[38:39]
    s_cbranch_scc1 L_sp_11
L_sp_11d:
    s_waitcnt vmcnt(1)
    s_barrier
L_rest:
    s_waitcnt vmcnt(0)
    s_endpgm
L_c_2:
    s_mov_b32 s58, 0
L_tag_12:
    buffer_load_dwordx2 v[14:15], off, s[28:31], 0 sc1
    s_waitcnt vmcnt(0)
    v_readfirstlane_b32 s48, v14
    v_readfirstlane_b32 s49, v15
    s_add_u32 s58, s58, 1
    s_cmp_gt_u32 s58, 400000
    s_cbranch_scc1 L_tag_12d
    s_cmp_eq_u32 s49, 0
    s_cbranch_scc1 L_tag_12
L_tag_12d:
    s_branch L_c_2r
L_c_3:
    s_mov_b32 s58, 0
    s_mov_b64 exec, 3
L_vp_13:
    buffer_load_dwordx2 v[8:9], v10, s[24:27], s65 offen sc1
    s_add_u32 s58, s58, 1
    s_cmp_gt_u32 s58, 400000
    s_waitcnt vmcnt(0)
    v_cmp_ne_u64 vcc, s[48:49], v[8:9]
    s_cbranch_scc1 L_vp_13d
    s_cbranch_vccnz L_vp_13
L_vp_13d:
    s_mov_b64 exec, -1
    s_lshl_b32 s51, s6, 13
    s_add_u32 m0, s51, 65536
    s_add_u32 s50, s64, 0
    buffer_load_dwordx4 v12, s[12:15], s50 offen offset:0 sc1 lds
    buffer_load_dwordx4 v12, s[12:15], s50 offen offset:1024 sc1 lds
    buffer_load_dwordx4 v12, s[12:15], s50 offen offset:2048 sc1 lds
    buffer_load_dwordx4 v12, s[12:15], s50 offen offset:3072 sc1 lds
    s_mov_b64 exec, 12
    buffer_load_dwordx2 v[8:9], v10, s[12:15], s65 offen sc1
    s_mov_b64 exec, -1
    s_branch L_c_3r
L_c_4:
    s_mov_b32 s58, 0
    s_mov_b64 exec, 12
L_vp_14:
    buffer_load_dwordx2 v[8:9], v10, s[24:27], s65 offen sc1
    s_add_u32 s58, s58, 1
    s_cmp_gt_u32 s58, 400000
    s_waitcnt vmcnt(0)
    v_cmp_ne_u64 vcc, s[48:49], v[8:9]
    s_cbranch_scc1 L_vp_14d
    s_cbranch_vccnz L_vp_14
L_vp_14d:
    s_mov_b64 exec, -1
    s_branch L_c_4r
L_c_5:
    v_mov_b32 v160, v11
    v_mov_b32 v161, v11
    v_mov_b32 v162, v11
    v_mov_b32 v163, v11
    v_mov_b32 v164, v11
    v_mov_b32 v165, v11
    v_mov_b32 v166, v11
    v_mov_b32 v167, v11
    s_branch L_c_5r
L_c_6:
    v_mov_b32 v168, v11
    v_mov_b32 v169, v11
    v_mov_b32 v170, v11
    v_mov_b32 v171, v11
    v_mov_b32 v172, v11
    v_mov_b32 v173, v11
    v_mov_b32 v174, v11
    v_mov_b32 v175, v11
    s_branch L_c_6r
L_c_7:
    v_mov_b32 v144, v11
    v_mov_b32 v145, v11
    v_mov_b32 v146, v11
    v_mov_b32 v147, v11
    v_mov_b32 v148, v11
    v_mov_b32 v149, v11
    v_mov_b32 v150, v11
    v_mov_b32 v151, v11
    s_branch L_c_7r
L_c_8:
    v_mov_b32 v152, v11
    v_mov_b32 v153, v11
    v_mov_b32 v154, v11
    v_mov_b32 v155, v11
    v_mov_b32 v156, v11
    v_mov_b32 v157, v11
    v_mov_b32 v158, v11
    v_mov_b32 v159, v11
    s_branch L_c_8r
L_c_9:
    s_lshl_b32 s50, s3, 6
    s_add_u32 s50, s50, s55
    s_lshl_b32 s64, s50, 15
    s_add_u32 s64, s64, 8388608
    s_lshl_b32 s65, s50, 12
    s_add_u32 s65, s65, 13107200
    v_lshlrev_b32 v10, 7, v1
    s_mov_b64 exec, 0x55555555
    buffer_load_dwordx2 v[8:9], v10, s[24:27], s65 offen sc1
    s_mov_b64 exec, -1
    s_branch L_c_9r
L_attnA:
    s_cmp_eq_u32 s56, 0
    s_cbranch_scc1 L_c_15
L_c_15r:
    ds_read_b128 v[176:179], v2 offset:49152
    ds_read_b128 v[180:183], v2 offset:50176
    s_mov_b64 exec, s[60:61]
    ds_read_b128 v[160:163], v3 offset:50176
    ds_read_b128 v[164:167], v3 offset:50432
    s_mov_b64 exec, -1
L_A_nh:
    s_mov_b64 exec, s[60:61]
    ds_read_b128 v[144:147], v3 offset:57344
    ds_read_b128 v[148:151], v3 offset:58368
    ds_read_b128 v[152:155], v3 offset:57600
    ds_read_b128 v[156:159], v3 offset:58624
    s_mov_b64 exec, -1
    s_nop 0
    v_pk_mul_f32 v[24:25], v[24:25], s[52:53]
    v_pk_mul_f32 v[26:27], v[26:27], s[52:53]
    v_pk_mul_f32 v[28:29], v[28:29], s[52:53]
    v_pk_mul_f32 v[30:31], v[30:31], s[52:53]
    v_cvt_pk_bf16_f32 v16, v24, v25
    v_cvt_pk_bf16_f32 v18, v28, v29
    v_cvt_pk_bf16_f32 v17, v26, v27
    v_cvt_pk_bf16_f32 v19, v30, v31
    s_nop 0
    v_permlane16_swap_b32 v16, v18
    v_permlane16_swap_b32 v17, v19
    s_nop 1
    v_mfma_f32_32x32x16_bf16 v[72:87], v[140:143], v[16:19], v[40:55]
    v_pk_mul_f32 v[32:33], v[32:33], s[52:53]
    v_pk_mul_f32 v[34:35], v[34:35], s[52:53]
    v_pk_mul_f32 v[36:37], v[36:37], s[52:53]
    v_pk_mul_f32 v[38:39], v[38:39], s[52:53]
    v_cvt_pk_bf16_f32 v20, v32, v33
    v_cvt_pk_bf16_f32 v22, v36, v37
    v_cvt_pk_bf16_f32 v21, v34, v35
    v_cvt_pk_bf16_f32 v23, v38, v39
    s_nop 0
    v_permlane16_swap_b32 v20, v22
    v_permlane16_swap_b32 v21, v23
    s_waitcnt lgkmcnt(0)
    s_nop 0
    v_mfma_f32_32x32x16_bf16 v[88:103], v[136:139], v[20:23], v[40:55]
    v_exp_f32 v72, v72
    v_exp_f32 v73, v73
    v_exp_f32 v74, v74
    v_exp_f32 v75, v75
    v_exp_f32 v76, v76
    v_exp_f32 v77, v77
    v_exp_f32 v78, v78
    v_exp_f32 v79, v79
    v_exp_f32 v80, v80
    v_exp_f32 v81, v81
    v_exp_f32 v82, v82
    v_exp_f32 v83, v83
    v_exp_f32 v84, v84
    v_exp_f32 v85, v85
    v_exp_f32 v86, v86
    v_exp_f32 v87, v87
    v_cvt_pk_bf16_f32 v24, v72, v73
    v_cvt_pk_bf16_f32 v25, v74, v75
    v_cvt_pk_bf16_f32 v26, v76, v77
    v_cvt_pk_bf16_f32 v27, v78, v79
    v_cvt_pk_bf16_f32 v28, v80, v81
    v_cvt_pk_bf16_f32 v29, v82, v83
    v_cvt_pk_bf16_f32 v30, v84, v85
    v_cvt_pk_bf16_f32 v31, v86, v87
    s_cmp_eq_u32 s56, 0
    s_cbranch_scc1 L_c_16
L_c_16r:
    v_mfma_f32_32x32x16_bf16 v[184:199], v[176:179], v[16:19], v[56:71]
    v_mfma_f32_32x32x16_bf16 v[200:215], v[180:183], v[20:23], v[56:71]
    v_exp_f32 v88, v88
    v_exp_f32 v89, v89
    v_exp_f32 v90, v90
    v_exp_f32 v91, v91
    v_mfma_f32_32x32x16_bf16 v[104:119], v[144:147], v[24:27], 0
    v_exp_f32 v92, v92
    v_exp_f32 v93, v93
    v_exp_f32 v94, v94
    v_exp_f32 v95, v95
    v_mfma_f32_32x32x16_bf16 v[104:119], v[148:151], v[28:31], v[104:119]
    v_exp_f32 v96, v96
    v_exp_f32 v97, v97
    v_exp_f32 v98, v98
    v_exp_f32 v99, v99
    v_exp_f32 v100, v100
    v_exp_f32 v101, v101
    v_exp_f32 v102, v102
    v_exp_f32 v103, v103
    v_cvt_pk_bf16_f32 v32, v88, v89
    v_cvt_pk_bf16_f32 v33, v90, v91
    v_cvt_pk_bf16_f32 v34, v92, v93
    v_cvt_pk_bf16_f32 v35, v94, v95
    v_cvt_pk_bf16_f32 v36, v96, v97
    v_cvt_pk_bf16_f32 v37, v98, v99
    v_cvt_pk_bf16_f32 v38, v100, v101
    v_cvt_pk_bf16_f32 v39, v102, v103
    s_cmp_eq_u32 s59, 0
    s_cbranch_scc1 L_A_first
    v_exp_f32 v192, v192
    v_exp_f32 v193, v193
    v_exp_f32 v194, v194
    v_exp_f32 v195, v195
    v_mfma_f32_32x32x16_bf16 v[120:135], v[152:155], v[32:35], 0
    v_exp_f32 v196, v196
    v_exp_f32 v197, v197
    v_exp_f32 v198, v198
    v_exp_f32 v199, v199
    v_mfma_f32_32x32x16_bf16 v[120:135], v[156:159], v[36:39], v[120:135]
    v_cvt_pk_bf16_f32 v184, v192, v193
    v_cvt_pk_bf16_f32 v185, v194, v195
    v_cvt_pk_bf16_f32 v186, v196, v197
    v_cvt_pk_bf16_f32 v187, v198, v199
    v_exp_f32 v208, v208
    v_exp_f32 v209, v209
    v_exp_f32 v210, v210
    v_exp_f32 v211, v211
    v_mfma_f32_32x32x16_bf16 v[104:119], v[160:163], v[184:187], v[104:119]
    v_exp_f32 v212, v212
    v_exp_f32 v213, v213
    v_exp_f32 v214, v214
    v_exp_f32 v215, v215
    v_cvt_pk_bf16_f32 v200, v208, v209
    v_cvt_pk_bf16_f32 v201, v210, v211
    v_cvt_pk_bf16_f32 v202, v212, v213
    v_cvt_pk_bf16_f32 v203, v214, v215
    s_nop 1
    v_mfma_f32_32x32x16_bf16 v[120:135], v[164:167], v[200:203], v[120:135]
    s_nop 0
L_A_norm:
    v_rcp_f32 v114, v112
    v_pk_add_f32 v[116:117], v[104:105], v[106:107]
    v_pk_add_f32 v[118:119], v[108:109], v[110:111]
    v_pk_mul_f32 v[104:105], v[104:105], v[114:115] op_sel_hi:[1,0]
    v_pk_mul_f32 v[106:107], v[106:107], v[114:115] op_sel_hi:[1,0]
    v_pk_mul_f32 v[108:109], v[108:109], v[114:115] op_sel_hi:[1,0]
    v_pk_mul_f32 v[110:111], v[110:111], v[114:115] op_sel_hi:[1,0]
    v_pk_add_f32 v[116:117], v[116:117], v[118:119]
    v_cvt_pk_bf16_f32 v24, v104, v105
    v_cvt_pk_bf16_f32 v25, v106, v107
    v_cvt_pk_bf16_f32 v26, v108, v109
    v_cvt_pk_bf16_f32 v27, v110, v111
    v_add_f32 v116, v116, v117
    v_fma_f32 v112, v116, 0, v112
    v_rcp_f32 v130, v128
    v_pk_add_f32 v[132:133], v[120:121], v[122:123]
    v_pk_add_f32 v[134:135], v[124:125], v[126:127]
    v_pk_mul_f32 v[120:121], v[120:121], v[130:131] op_sel_hi:[1,0]
    v_pk_mul_f32 v[122:123], v[122:123], v[130:131] op_sel_hi:[1,0]
    v_pk_mul_f32 v[124:125], v[124:125], v[130:131] op_sel_hi:[1,0]
    v_pk_mul_f32 v[126:127], v[126:127], v[130:131] op_sel_hi:[1,0]
    v_pk_add_f32 v[132:133], v[132:133], v[134:135]
    v_cvt_pk_bf16_f32 v28, v120, v121
    v_cvt_pk_bf16_f32 v29, v122, v123
    v_cvt_pk_bf16_f32 v30, v124, v125
    v_cvt_pk_bf16_f32 v31, v126, v127
    v_add_f32 v132, v132, v133
    v_fma_f32 v128, v132, 0, v128
    v_subrev_u32 v112, 0x2b800000, v112
    v_subrev_u32 v128, 0x2b800000, v128
    v_max_u32 v112, v112, v128
    v_cmp_lt_u32 vcc, 0x28000000, v112
    s_cbranch_vccnz L_A_slow
L_A_ok:
    s_setprio 2
    buffer_store_dwordx4 v[24:27], v12, s[24:27], s68 offen sc1
    buffer_store_dwordx4 v[28:31], v12, s[24:27], s68 offen offset:1024 sc1
    s_setprio 0
    v_bfe_u32 v4, v1, 2, 3
    s_lshl_b32 s50, s6, 3
    v_add_u32 v4, s50, v4
    v_lshlrev_b32 v4, 10, v4
    v_lshrrev_b32 v5, 5, v1
    v_lshl_add_u32 v4, v5, 6, v4
    v_and_b32 v5, 3, v1
    v_lshl_add_u32 v4, v5, 4, v4
    v_and_b32 v5, 16, v1
    v_lshlrev_b32 v5, 1, v5
    v_xor_b32 v4, v5, v4
    s_and_b32 s50, s54, 7
    s_lshl_b32 s50, s50, 7
    v_add_u32 v4, s50, v4
    s_add_u32 m0, s7, 65536
    s_mov_b32 s50, 0
    buffer_load_dwordx4 v4, s[16:19], s50 offen lds
    s_add_u32 m0, s7, 73728
    s_mov_b32 s50, 65536
    buffer_load_dwordx4 v4, s[16:19], s50 offen lds
    s_add_u32 m0, s7, 81920
    s_mov_b32 s50, 131072
    buffer_load_dwordx4 v4, s[16:19], s50 offen lds
    s_add_u32 m0, s7, 90112
    s_mov_b32 s50, 196608
    buffer_load_dwordx4 v4, s[16:19], s50 offen lds
    s_add_u32 m0, s7, 98304
    s_mov_b32 s50, 262144
    buffer_load_dwordx4 v4, s[16:19], s50 offen lds
    s_add_u32 m0, s7, 106496
    s_mov_b32 s50, 327680
    buffer_load_dwordx4 v4, s[16:19], s50 offen lds
    s_add_u32 m0, s7, 114688
    s_mov_b32 s50, 393216
    buffer_load_dwordx4 v4, s[16:19], s50 offen lds
    s_add_u32 m0, s7, 122880
    s_mov_b32 s50, 458752
    buffer_load_dwordx4 v4, s[16:19], s50 offen lds
    s_cmp_lt_u32 s6, 4
    s_cbranch_scc0 L_youngA
    s_and_b32 s67, s54, 3
    s_lshl_b32 s50, s3, 6
    s_add_u32 s50, s50, s55
    s_lshl_b32 s64, s50, 15
    s_add_u32 s64, s64, 8388608
    s_lshl_b32 s65, s50, 12
    s_add_u32 s65, s65, 13107200
    v_lshlrev_b32 v10, 7, v1
    s_brev_b32 s36, s67
    s_lshr_b32 s36, s36, 20
    s_add_u32 s32, s36, s64
    s_add_u32 s67, s67, 1
    s_and_b32 s67, s67, 3
    s_brev_b32 s36, s67
    s_lshr_b32 s36, s36, 20
    s_add_u32 s33, s36, s64
    s_add_u32 s67, s67, 1
    s_and_b32 s67, s67, 3
    s_brev_b32 s36, s67
    s_lshr_b32 s36, s36, 20
    s_add_u32 s34, s36, s64
    s_add_u32 s67, s67, 1
    s_and_b32 s67, s67, 3
    s_brev_b32 s36, s67
    s_lshr_b32 s36, s36, 20
    s_add_u32 s35, s36, s64
    s_add_u32 s67, s67, 1
    s_and_b32 s67, s67, 3
    v_and_b32 v5, 0xf0, v12
    v_bfe_u32 v36, v1, 4, 1
    v_lshl_add_u32 v5, v36, 9, v5
    v_lshrrev_b32 v36, 5, v1
    v_lshl_add_u32 v5, v36, 12, v5
    s_mov_b32 s53, 65536
L_p3all:
    s_waitcnt vmcnt(8)
    s_barrier
    v_bfe_u32 v36, v1, 2, 2
    v_lshlrev_b32 v2, 6, v36
    v_and_b32 v36, 3, v1
    v_lshl_add_u32 v2, v36, 3, v2
    v_bfe_u32 v36, v1, 4, 1
    v_mul_u32_u24 v36, 288, v36
    v_add_u32 v2, v2, v36
    v_lshrrev_b32 v36, 5, v1
    v_lshl_add_u32 v2, v36, 13, v2
    v_add_u32 v2, s53, v2
    v_xor_b32 v3, 32, v2
    s_and_b32 s50, s32, 0xc00
    s_lshl_b32 s50, s50, 1
    v_add_u32 v0, s50, v2
    v_add_u32 v4, s50, v3
    s_and_b32 s50, s33, 0xc00
    s_lshl_b32 s50, s50, 1
    v_add_u32 v6, s50, v2
    v_add_u32 v16, s50, v3
    s_lshl_b32 s50, s6, 12
    s_add_u32 s50, s50, 131072
    v_lshrrev_b32 v36, 5, v1
    v_and_b32 v37, 7, v1
    v_xor_b32 v36, v36, v37
    v_and_b32 v18, 15, v1
    v_lshlrev_b32 v18, 7, v18
    v_lshl_add_u32 v18, v36, 4, v18
    v_bfe_u32 v36, v1, 4, 1
    v_lshl_add_u32 v18, v36, 3, v18
    v_add_u32 v18, s50, v18
    v_xor_b32 v19, 32, v18
    v_xor_b32 v20, 64, v18
    v_xor_b32 v21, 96, v18
    v_lshrrev_b32 v36, 3, v1
    v_xor_b32 v17, v36, v37
    v_lshlrev_b32 v17, 4, v17
    v_lshl_add_u32 v17, v36, 7, v17
    v_add_u32 v17, s50, v17
    v_lshlrev_b32 v7, 11, v36
    v_lshl_add_u32 v7, v37, 4, v7
    s_lshl_b32 s68, s55, 16
    s_lshl_b32 s51, s3, 10
    s_add_u32 s68, s68, s51
    s_and_b32 s51, s54, 7
    s_lshl_b32 s51, s51, 7
    s_add_u32 s68, s68, s51
    s_waitcnt vmcnt(0)
    s_barrier
    buffer_load_dwordx4 v[136:139], v5, s[24:27], s32 offen offset:0 sc1
    buffer_load_dwordx4 v[140:143], v5, s[24:27], s32 offen offset:256 sc1
    s_add_u32 s37, s32, 8192
    buffer_load_dwordx4 v[144:147], v5, s[24:27], s37 offen offset:0 sc1
    buffer_load_dwordx4 v[148:151], v5, s[24:27], s37 offen offset:256 sc1
    s_add_u32 s37, s32, 16384
    buffer_load_dwordx4 v[152:155], v5, s[24:27], s37 offen offset:0 sc1
    buffer_load_dwordx4 v[156:159], v5, s[24:27], s37 offen offset:256 sc1
    s_add_u32 s37, s32, 24576
    buffer_load_dwordx4 v[160:163], v5, s[24:27], s37 offen offset:0 sc1
    buffer_load_dwordx4 v[164:167], v5, s[24:27], s37 offen offset:256 sc1
L_p3go:
    ds_read_b64_tr_b16 v[72:73], v0 offset:0
    ds_read_b64_tr_b16 v[74:75], v0 offset:1024
    ds_read_b64_tr_b16 v[76:77], v4 offset:0
    ds_read_b64_tr_b16 v[78:79], v4 offset:1024
    ds_read_b64_tr_b16 v[80:81], v0 offset:512
    ds_read_b64_tr_b16 v[82:83], v0 offset:1536
    ds_read_b64_tr_b16 v[84:85], v4 offset:512
    ds_read_b64_tr_b16 v[86:87], v4 offset:1536
    ds_read_b64_tr_b16 v[88:89], v0 offset:16384
    ds_read_b64_tr_b16 v[90:91], v0 offset:17408
    ds_read_b64_tr_b16 v[92:93], v4 offset:16384
    ds_read_b64_tr_b16 v[94:95], v4 offset:17408
    ds_read_b64_tr_b16 v[96:97], v0 offset:16896
    ds_read_b64_tr_b16 v[98:99], v0 offset:17920
    ds_read_b64_tr_b16 v[100:101], v4 offset:16896
    ds_read_b64_tr_b16 v[102:103], v4 offset:17920
    s_waitcnt vmcnt(6) lgkmcnt(8)
    v_mfma_f32_16x16x32_bf16 v[40:43], v[72:75], v[136:139], 0
    ds_read_b64_tr_b16 v[104:105], v0 offset:32768
    v_mfma_f32_16x16x32_bf16 v[44:47], v[76:79], v[136:139], 0
    ds_read_b64_tr_b16 v[106:107], v0 offset:33792
    buffer_load_dwordx4 v[168:171], v5, s[24:27], s33 offen offset:0 sc1
    v_mfma_f32_16x16x32_bf16 v[48:51], v[80:83], v[136:139], 0
    ds_read_b64_tr_b16 v[108:109], v4 offset:32768
    v_mfma_f32_16x16x32_bf16 v[52:55], v[84:87], v[136:139], 0
    ds_read_b64_tr_b16 v[110:111], v4 offset:33792
    v_mfma_f32_16x16x32_bf16 v[56:59], v[72:75], v[140:143], 0
    ds_read_b64_tr_b16 v[112:113], v0 offset:33280
    v_mfma_f32_16x16x32_bf16 v[60:63], v[76:79], v[140:143], 0
    ds_read_b64_tr_b16 v[114:115], v0 offset:34304
    buffer_load_dwordx4 v[172:175], v5, s[24:27], s33 offen offset:256 sc1
    v_mfma_f32_16x16x32_bf16 v[64:67], v[80:83], v[140:143], 0
    ds_read_b64_tr_b16 v[116:117], v4 offset:33280
    v_mfma_f32_16x16x32_bf16 v[68:71], v[84:87], v[140:143], 0
    ds_read_b64_tr_b16 v[118:119], v4 offset:34304
    s_waitcnt vmcnt(6) lgkmcnt(8)
    v_mfma_f32_16x16x32_bf16 v[40:43], v[88:91], v[144:147], v[40:43]
    ds_read_b64_tr_b16 v[120:121], v0 offset:49152
    v_mfma_f32_16x16x32_bf16 v[44:47], v[92:95], v[144:147], v[44:47]
    ds_read_b64_tr_b16 v[122:123], v0 offset:50176
    s_add_u32 s37, s33, 8192
    buffer_load_dwordx4 v[176:179], v5, s[24:27], s37 offen offset:0 sc1
    v_mfma_f32_16x16x32_bf16 v[48:51], v[96:99], v[144:147], v[48:51]
    ds_read_b64_tr_b16 v[124:125], v4 offset:49152
    v_mfma_f32_16x16x32_bf16 v[52:55], v[100:103], v[144:147], v[52:55]
    ds_read_b64_tr_b16 v[126:127], v4 offset:50176
    v_mfma_f32_16x16x32_bf16 v[56:59], v[88:91], v[148:151], v[56:59]
    ds_read_b64_tr_b16 v[128:129], v0 offset:49664
    v_mfma_f32_16x16x32_bf16 v[60:63], v[92:95], v[148:151], v[60:63]
    ds_read_b64_tr_b16 v[130:131], v0 offset:50688
    buffer_load_dwordx4 v[180:183], v5, s[24:27], s37 offen offset:256 sc1
    v_mfma_f32_16x16x32_bf16 v[64:67], v[96:99], v[148:151], v[64:67]
    ds_read_b64_tr_b16 v[132:133], v4 offset:49664
    v_mfma_f32_16x16x32_bf16 v[68:71], v[100:103], v[148:151], v[68:71]
    ds_read_b64_tr_b16 v[134:135], v4 offset:50688
    s_and_b32 s50, s34, 0xc00
    s_lshl_b32 s50, s50, 1
    v_add_u32 v0, s50, v2
    v_add_u32 v4, s50, v3
    s_waitcnt vmcnt(6) lgkmcnt(8)
    v_mfma_f32_16x16x32_bf16 v[40:43], v[104:107], v[152:155], v[40:43]
    ds_read_b64_tr_b16 v[72:73], v6 offset:0
    v_mfma_f32_16x16x32_bf16 v[44:47], v[108:111], v[152:155], v[44:47]
    ds_read_b64_tr_b16 v[74:75], v6 offset:1024
    s_add_u32 s37, s33, 16384
    buffer_load_dwordx4 v[184:187], v5, s[24:27], s37 offen offset:0 sc1
    v_mfma_f32_16x16x32_bf16 v[48:51], v[112:115], v[152:155], v[48:51]
    ds_read_b64_tr_b16 v[76:77], v16 offset:0
    v_mfma_f32_16x16x32_bf16 v[52:55], v[116:119], v[152:155], v[52:55]
    ds_read_b64_tr_b16 v[78:79], v16 offset:1024
    v_mfma_f32_16x16x32_bf16 v[56:59], v[104:107], v[156:159], v[56:59]
    ds_read_b64_tr_b16 v[80:81], v6 offset:512
    v_mfma_f32_16x16x32_bf16 v[60:63], v[108:111], v[156:159], v[60:63]
    ds_read_b64_tr_b16 v[82:83], v6 offset:1536
    buffer_load_dwordx4 v[188:191], v5, s[24:27], s37 offen offset:256 sc1
    v_mfma_f32_16x16x32_bf16 v[64:67], v[112:115], v[156:159], v[64:67]
    ds_read_b64_tr_b16 v[84:85], v16 offset:512
    v_mfma_f32_16x16x32_bf16 v[68:71], v[116:119], v[156:159], v[68:71]
    ds_read_b64_tr_b16 v[86:87], v16 offset:1536
    s_waitcnt vmcnt(6) lgkmcnt(8)
    v_mfma_f32_16x16x32_bf16 v[40:43], v[120:123], v[160:163], v[40:43]
    ds_read_b64_tr_b16 v[88:89], v6 offset:16384
    v_mfma_f32_16x16x32_bf16 v[44:47], v[124:127], v[160:163], v[44:47]
    ds_read_b64_tr_b16 v[90:91], v6 offset:17408
    s_add_u32 s37, s33, 24576
    buffer_load_dwordx4 v[192:195], v5, s[24:27], s37 offen offset:0 sc1
    v_mfma_f32_16x16x32_bf16 v[48:51], v[128:131], v[160:163], v[48:51]
    ds_read_b64_tr_b16 v[92:93], v16 offset:16384
    v_mfma_f32_16x16x32_bf16 v[52:55], v[132:135], v[160:163], v[52:55]
    ds_read_b64_tr_b16 v[94:95], v16 offset:17408
    v_mfma_f32_16x16x32_bf16 v[56:59], v[120:123], v[164:167], v[56:59]
    ds_read_b64_tr_b16 v[96:97], v6 offset:16896
    v_mfma_f32_16x16x32_bf16 v[60:63], v[124:127], v[164:167], v[60:63]
    ds_read_b64_tr_b16 v[98:99], v6 offset:17920
    buffer_load_dwordx4 v[196:199], v5, s[24:27], s37 offen offset:256 sc1
    v_mfma_f32_16x16x32_bf16 v[64:67], v[128:131], v[164:167], v[64:67]
    ds_read_b64_tr_b16 v[100:101], v16 offset:16896
    v_mfma_f32_16x16x32_bf16 v[68:71], v[132:135], v[164:167], v[68:71]
    ds_read_b64_tr_b16 v[102:103], v16 offset:17920
    s_cmp_eq_u32 s3, 0
    s_cbranch_scc1 L_p3b
    s_lshl_b32 s50, s6, 12
    s_add_u32 s50, s50, 131072
    v_lshrrev_b32 v36, 5, v1
    v_and_b32 v37, 7, v1
    v_xor_b32 v36, v36, v37
    v_and_b32 v18, 15, v1
    v_lshlrev_b32 v18, 7, v18
    v_lshl_add_u32 v18, v36, 4, v18
    v_bfe_u32 v36, v1, 4, 1
    v_lshl_add_u32 v18, v36, 3, v18
    v_add_u32 v18, s50, v18
    v_xor_b32 v19, 32, v18
    v_xor_b32 v20, 64, v18
    v_xor_b32 v21, 96, v18
    v_lshrrev_b32 v36, 3, v1
    v_xor_b32 v17, v36, v37
    v_lshlrev_b32 v17, 4, v17
    v_lshl_add_u32 v17, v36, 7, v17
    v_add_u32 v17, s50, v17
    v_lshlrev_b32 v7, 11, v36
    v_lshl_add_u32 v7, v37, 4, v7
    s_lshl_b32 s68, s55, 16
    s_lshl_b32 s51, s3, 10
    s_add_u32 s68, s68, s51
    s_and_b32 s51, s54, 7
    s_lshl_b32 s51, s51, 7
    s_add_u32 s68, s68, s51
    s_barrier
L_p3b:
    s_waitcnt vmcnt(6) lgkmcnt(8)
    v_mfma_f32_16x16x32_bf16 v[40:43], v[72:75], v[168:171], v[40:43]
    ds_read_b64_tr_b16 v[104:105], v6 offset:32768
    v_mfma_f32_16x16x32_bf16 v[44:47], v[76:79], v[168:171], v[44:47]
    ds_read_b64_tr_b16 v[106:107], v6 offset:33792
    buffer_load_dwordx4 v[200:203], v5, s[24:27], s34 offen offset:0 sc1
    v_mfma_f32_16x16x32_bf16 v[48:51], v[80:83], v[168:171], v[48:51]
    ds_read_b64_tr_b16 v[108:109], v16 offset:32768
    v_mfma_f32_16x16x32_bf16 v[52:55], v[84:87], v[168:171], v[52:55]
    ds_read_b64_tr_b16 v[110:111], v16 offset:33792
    v_mfma_f32_16x16x32_bf16 v[56:59], v[72:75], v[172:175], v[56:59]
    ds_read_b64_tr_b16 v[112:113], v6 offset:33280
    v_mfma_f32_16x16x32_bf16 v[60:63], v[76:79], v[172:175], v[60:63]
    ds_read_b64_tr_b16 v[114:115], v6 offset:34304
    buffer_load_dwordx4 v[204:207], v5, s[24:27], s34 offen offset:256 sc1
    v_mfma_f32_16x16x32_bf16 v[64:67], v[80:83], v[172:175], v[64:67]
    ds_read_b64_tr_b16 v[116:117], v16 offset:33280
    v_mfma_f32_16x16x32_bf16 v[68:71], v[84:87], v[172:175], v[68:71]
    ds_read_b64_tr_b16 v[118:119], v16 offset:34304
    s_waitcnt vmcnt(6) lgkmcnt(8)
    v_mfma_f32_16x16x32_bf16 v[40:43], v[88:91], v[176:179], v[40:43]
    ds_read_b64_tr_b16 v[120:121], v6 offset:49152
    v_mfma_f32_16x16x32_bf16 v[44:47], v[92:95], v[176:179], v[44:47]
    ds_read_b64_tr_b16 v[122:123], v6 offset:50176
    s_add_u32 s37, s34, 8192
    buffer_load_dwordx4 v[208:211], v5, s[24:27], s37 offen offset:0 sc1
    v_mfma_f32_16x16x32_bf16 v[48:51], v[96:99], v[176:179], v[48:51]
    ds_read_b64_tr_b16 v[124:125], v16 offset:49152
    v_mfma_f32_16x16x32_bf16 v[52:55], v[100:103], v[176:179], v[52:55]
    ds_read_b64_tr_b16 v[126:127], v16 offset:50176
    v_mfma_f32_16x16x32_bf16 v[56:59], v[88:91], v[180:183], v[56:59]
    ds_read_b64_tr_b16 v[128:129], v6 offset:49664
    v_mfma_f32_16x16x32_bf16 v[60:63], v[92:95], v[180:183], v[60:63]
    ds_read_b64_tr_b16 v[130:131], v6 offset:50688
    buffer_load_dwordx4 v[212:215], v5, s[24:27], s37 offen offset:256 sc1
    v_mfma_f32_16x16x32_bf16 v[64:67], v[96:99], v[180:183], v[64:67]
    ds_read_b64_tr_b16 v[132:133], v16 offset:49664
    v_mfma_f32_16x16x32_bf16 v[68:71], v[100:103], v[180:183], v[68:71]
    ds_read_b64_tr_b16 v[134:135], v16 offset:50688
    s_and_b32 s50, s35, 0xc00
    s_lshl_b32 s50, s50, 1
    v_add_u32 v6, s50, v2
    v_add_u32 v16, s50, v3
    s_waitcnt vmcnt(6) lgkmcnt(8)
    v_mfma_f32_16x16x32_bf16 v[40:43], v[104:107], v[184:187], v[40:43]
    ds_read_b64_tr_b16 v[72:73], v0 offset:0
    v_mfma_f32_16x16x32_bf16 v[44:47], v[108:111], v[184:187], v[44:47]
    ds_read_b64_tr_b16 v[74:75], v0 offset:1024
    s_add_u32 s37, s34, 16384
    buffer_load_dwordx4 v[216:219], v5, s[24:27], s37 offen offset:0 sc1
    v_mfma_f32_16x16x32_bf16 v[48:51], v[112:115], v[184:187], v[48:51]
    ds_read_b64_tr_b16 v[76:77], v4 offset:0
    v_mfma_f32_16x16x32_bf16 v[52:55], v[116:119], v[184:187], v[52:55]
    ds_read_b64_tr_b16 v[78:79], v4 offset:1024
    v_mfma_f32_16x16x32_bf16 v[56:59], v[104:107], v[188:191], v[56:59]
    ds_read_b64_tr_b16 v[80:81], v0 offset:512
    v_mfma_f32_16x16x32_bf16 v[60:63], v[108:111], v[188:191], v[60:63]
    ds_read_b64_tr_b16 v[82:83], v0 offset:1536
    buffer_load_dwordx4 v[220:223], v5, s[24:27], s37 offen offset:256 sc1
    v_mfma_f32_16x16x32_bf16 v[64:67], v[112:115], v[188:191], v[64:67]
    ds_read_b64_tr_b16 v[84:85], v4 offset:512
    v_mfma_f32_16x16x32_bf16 v[68:71], v[116:119], v[188:191], v[68:71]
    ds_read_b64_tr_b16 v[86:87], v4 offset:1536
    s_waitcnt vmcnt(6) lgkmcnt(8)
    v_mfma_f32_16x16x32_bf16 v[40:43], v[120:123], v[192:195], v[40:43]
    ds_read_b64_tr_b16 v[88:89], v0 offset:16384
    v_mfma_f32_16x16x32_bf16 v[44:47], v[124:127], v[192:195], v[44:47]
    ds_read_b64_tr_b16 v[90:91], v0 offset:17408
    s_add_u32 s37, s34, 24576
    buffer_load_dwordx4 v[224:227], v5, s[24:27], s37 offen offset:0 sc1
    v_mfma_f32_16x16x32_bf16 v[48:51], v[128:131], v[192:195], v[48:51]
    ds_read_b64_tr_b16 v[92:93], v4 offset:16384
    v_mfma_f32_16x16x32_bf16 v[52:55], v[132:135], v[192:195], v[52:55]
    ds_read_b64_tr_b16 v[94:95], v4 offset:17408
    v_mfma_f32_16x16x32_bf16 v[56:59], v[120:123], v[196:199], v[56:59]
    ds_read_b64_tr_b16 v[96:97], v0 offset:16896
    v_mfma_f32_16x16x32_bf16 v[60:63], v[124:127], v[196:199], v[60:63]
    ds_read_b64_tr_b16 v[98:99], v0 offset:17920
    buffer_load_dwordx4 v[228:231], v5, s[24:27], s37 offen offset:256 sc1
    v_mfma_f32_16x16x32_bf16 v[64:67], v[128:131], v[196:199], v[64:67]
    ds_read_b64_tr_b16 v[100:101], v4 offset:16896
    v_mfma_f32_16x16x32_bf16 v[68:71], v[132:135], v[196:199], v[68:71]
    ds_read_b64_tr_b16 v[102:103], v4 offset:17920
    s_waitcnt vmcnt(6) lgkmcnt(8)
    v_mfma_f32_16x16x32_bf16 v[40:43], v[72:75], v[200:203], v[40:43]
    ds_read_b64_tr_b16 v[104:105], v0 offset:32768
    v_mfma_f32_16x16x32_bf16 v[44:47], v[76:79], v[200:203], v[44:47]
    ds_read_b64_tr_b16 v[106:107], v0 offset:33792
    buffer_load_dwordx4 v[232:235], v5, s[24:27], s35 offen offset:0 sc1
    v_mfma_f32_16x16x32_bf16 v[48:51], v[80:83], v[200:203], v[48:51]
    ds_read_b64_tr_b16 v[108:109], v4 offset:32768
    v_mfma_f32_16x16x32_bf16 v[52:55], v[84:87], v[200:203], v[52:55]
    ds_read_b64_tr_b16 v[110:111], v4 offset:33792
    v_mfma_f32_16x16x32_bf16 v[56:59], v[72:75], v[204:207], v[56:59]
    ds_read_b64_tr_b16 v[112:113], v0 offset:33280
    v_mfma_f32_16x16x32_bf16 v[60:63], v[76:79], v[204:207], v[60:63]
    ds_read_b64_tr_b16 v[114:115], v0 offset:34304
    buffer_load_dwordx4 v[236:239], v5, s[24:27], s35 offen offset:256 sc1
    v_mfma_f32_16x16x32_bf16 v[64:67], v[80:83], v[204:207], v[64:67]
    ds_read_b64_tr_b16 v[116:117], v4 offset:33280
    v_mfma_f32_16x16x32_bf16 v[68:71], v[84:87], v[204:207], v[68:71]
    ds_read_b64_tr_b16 v[118:119], v4 offset:34304
    s_waitcnt vmcnt(6) lgkmcnt(8)
    v_mfma_f32_16x16x32_bf16 v[40:43], v[88:91], v[208:211], v[40:43]
    ds_read_b64_tr_b16 v[120:121], v0 offset:49152
    v_mfma_f32_16x16x32_bf16 v[44:47], v[92:95], v[208:211], v[44:47]
    ds_read_b64_tr_b16 v[122:123], v0 offset:50176
    s_add_u32 s37, s35, 8192
    buffer_load_dwordx4 v[240:243], v5, s[24:27], s37 offen offset:0 sc1
    v_mfma_f32_16x16x32_bf16 v[48:51], v[96:99], v[208:211], v[48:51]
    ds_read_b64_tr_b16 v[124:125], v4 offset:49152
    v_mfma_f32_16x16x32_bf16 v[52:55], v[100:103], v[208:211], v[52:55]
    ds_read_b64_tr_b16 v[126:127], v4 offset:50176
    v_mfma_f32_16x16x32_bf16 v[56:59], v[88:91], v[212:215], v[56:59]
    ds_read_b64_tr_b16 v[128:129], v0 offset:49664
    v_mfma_f32_16x16x32_bf16 v[60:63], v[92:95], v[212:215], v[60:63]
    ds_read_b64_tr_b16 v[130:131], v0 offset:50688
    buffer_load_dwordx4 v[244:247], v5, s[24:27], s37 offen offset:256 sc1
    v_mfma_f32_16x16x32_bf16 v[64:67], v[96:99], v[212:215], v[64:67]
    ds_read_b64_tr_b16 v[132:133], v4 offset:49664
    v_mfma_f32_16x16x32_bf16 v[68:71], v[100:103], v[212:215], v[68:71]
    ds_read_b64_tr_b16 v[134:135], v4 offset:50688
    s_waitcnt vmcnt(6) lgkmcnt(8)
    v_mfma_f32_16x16x32_bf16 v[40:43], v[104:107], v[216:219], v[40:43]
    ds_read_b64_tr_b16 v[72:73], v6 offset:0
    v_mfma_f32_16x16x32_bf16 v[44:47], v[108:111], v[216:219], v[44:47]
    ds_read_b64_tr_b16 v[74:75], v6 offset:1024
    s_add_u32 s37, s35, 16384
    buffer_load_dwordx4 v[248:251], v5, s[24:27], s37 offen offset:0 sc1
    v_mfma_f32_16x16x32_bf16 v[48:51], v[112:115], v[216:219], v[48:51]
    ds_read_b64_tr_b16 v[76:77], v16 offset:0
    v_mfma_f32_16x16x32_bf16 v[52:55], v[116:119], v[216:219], v[52:55]
    ds_read_b64_tr_b16 v[78:79], v16 offset:1024
    v_mfma_f32_16x16x32_bf16 v[56:59], v[104:107], v[220:223], v[56:59]
    ds_read_b64_tr_b16 v[80:81], v6 offset:512
    v_mfma_f32_16x16x32_bf16 v[60:63], v[108:111], v[220:223], v[60:63]
    ds_read_b64_tr_b16 v[82:83], v6 offset:1536
    s_add_u32 s37, s35, 24576
    buffer_load_dwordx4 v[252:255], v5, s[24:27], s37 offen offset:0 sc1
    v_mfma_f32_16x16x32_bf16 v[64:67], v[112:115], v[220:223], v[64:67]
    ds_read_b64_tr_b16 v[84:85], v16 offset:512
    v_mfma_f32_16x16x32_bf16 v[68:71], v[116:119], v[220:223], v[68:71]
    ds_read_b64_tr_b16 v[86:87], v16 offset:1536
    s_waitcnt vmcnt(6) lgkmcnt(8)
    v_mfma_f32_16x16x32_bf16 v[40:43], v[120:123], v[224:227], v[40:43]
    ds_read_b64_tr_b16 v[88:89], v6 offset:16384
    v_mfma_f32_16x16x32_bf16 v[44:47], v[124:127], v[224:227], v[44:47]
    ds_read_b64_tr_b16 v[90:91], v6 offset:17408
    s_add_u32 s37, s35, 16384
    buffer_load_dwordx4 v[24:27], v5, s[24:27], s37 offen offset:256 sc1
    v_mfma_f32_16x16x32_bf16 v[48:51], v[128:131], v[224:227], v[48:51]
    ds_read_b64_tr_b16 v[92:93], v16 offset:16384
    v_mfma_f32_16x16x32_bf16 v[52:55], v[132:135], v[224:227], v[52:55]
    ds_read_b64_tr_b16 v[94:95], v16 offset:17408
    v_mfma_f32_16x16x32_bf16 v[56:59], v[120:123], v[228:231], v[56:59]
    ds_read_b64_tr_b16 v[96:97], v6 offset:16896
    v_mfma_f32_16x16x32_bf16 v[60:63], v[124:127], v[228:231], v[60:63]
    ds_read_b64_tr_b16 v[98:99], v6 offset:17920
    s_add_u32 s37, s35, 24576
    buffer_load_dwordx4 v[28:31], v5, s[24:27], s37 offen offset:256 sc1
    v_mfma_f32_16x16x32_bf16 v[64:67], v[128:131], v[228:231], v[64:67]
    ds_read_b64_tr_b16 v[100:101], v16 offset:16896
    v_mfma_f32_16x16x32_bf16 v[68:71], v[132:135], v[228:231], v[68:71]
    ds_read_b64_tr_b16 v[102:103], v16 offset:17920
    s_waitcnt vmcnt(6) lgkmcnt(8)
    v_mfma_f32_16x16x32_bf16 v[40:43], v[72:75], v[232:235], v[40:43]
    ds_read_b64_tr_b16 v[104:105], v6 offset:32768
    v_mfma_f32_16x16x32_bf16 v[44:47], v[76:79], v[232:235], v[44:47]
    ds_read_b64_tr_b16 v[106:107], v6 offset:33792
    v_mfma_f32_16x16x32_bf16 v[48:51], v[80:83], v[232:235], v[48:51]
    ds_read_b64_tr_b16 v[108:109], v16 offset:32768
    v_mfma_f32_16x16x32_bf16 v[52:55], v[84:87], v[232:235], v[52:55]
    ds_read_b64_tr_b16 v[110:111], v16 offset:33792
    v_mfma_f32_16x16x32_bf16 v[56:59], v[72:75], v[236:239], v[56:59]
    ds_read_b64_tr_b16 v[112:113], v6 offset:33280
    v_mfma_f32_16x16x32_bf16 v[60:63], v[76:79], v[236:239], v[60:63]
    ds_read_b64_tr_b16 v[114:115], v6 offset:34304
    v_mfma_f32_16x16x32_bf16 v[64:67], v[80:83], v[236:239], v[64:67]
    ds_read_b64_tr_b16 v[116:117], v16 offset:33280
    v_mfma_f32_16x16x32_bf16 v[68:71], v[84:87], v[236:239], v[68:71]
    ds_read_b64_tr_b16 v[118:119], v16 offset:34304
    s_waitcnt vmcnt(4) lgkmcnt(8)
    v_mfma_f32_16x16x32_bf16 v[40:43], v[88:91], v[240:243], v[40:43]
    ds_read_b64_tr_b16 v[120:121], v6 offset:49152
    v_mfma_f32_16x16x32_bf16 v[44:47], v[92:95], v[240:243], v[44:47]
    ds_read_b64_tr_b16 v[122:123], v6 offset:50176
    v_mfma_f32_16x16x32_bf16 v[48:51], v[96:99], v[240:243], v[48:51]
    ds_read_b64_tr_b16 v[124:125], v16 offset:49152
    v_mfma_f32_16x16x32_bf16 v[52:55], v[100:103], v[240:243], v[52:55]
    ds_read_b64_tr_b16 v[126:127], v16 offset:50176
    v_mfma_f32_16x16x32_bf16 v[56:59], v[88:91], v[244:247], v[56:59]
    ds_read_b64_tr_b16 v[128:129], v6 offset:49664
    v_mfma_f32_16x16x32_bf16 v[60:63], v[92:95], v[244:247], v[60:63]
    ds_read_b64_tr_b16 v[130:131], v6 offset:50688
    v_mfma_f32_16x16x32_bf16 v[64:67], v[96:99], v[244:247], v[64:67]
    ds_read_b64_tr_b16 v[132:133], v16 offset:49664
    v_mfma_f32_16x16x32_bf16 v[68:71], v[100:103], v[244:247], v[68:71]
    ds_read_b64_tr_b16 v[134:135], v16 offset:50688
    s_waitcnt vmcnt(3) lgkmcnt(8)
    v_mfma_f32_16x16x32_bf16 v[40:43], v[104:107], v[248:251], v[40:43]
    v_mfma_f32_16x16x32_bf16 v[44:47], v[108:111], v[248:251], v[44:47]
    v_mfma_f32_16x16x32_bf16 v[48:51], v[112:115], v[248:251], v[48:51]
    v_mfma_f32_16x16x32_bf16 v[52:55], v[116:119], v[248:251], v[52:55]
    s_waitcnt vmcnt(2) lgkmcnt(0)
    v_mfma_f32_16x16x32_bf16 v[40:43], v[120:123], v[252:255], v[40:43]
    v_mfma_f32_16x16x32_bf16 v[44:47], v[124:127], v[252:255], v[44:47]
    v_mfma_f32_16x16x32_bf16 v[48:51], v[128:131], v[252:255], v[48:51]
    v_mfma_f32_16x16x32_bf16 v[52:55], v[132:135], v[252:255], v[52:55]
    s_waitcnt vmcnt(1)
    v_mfma_f32_16x16x32_bf16 v[56:59], v[104:107], v[24:27], v[56:59]
    v_mfma_f32_16x16x32_bf16 v[60:63], v[108:111], v[24:27], v[60:63]
    v_mfma_f32_16x16x32_bf16 v[64:67], v[112:115], v[24:27], v[64:67]
    v_mfma_f32_16x16x32_bf16 v[68:71], v[116:119], v[24:27], v[68:71]
    v_cvt_pk_bf16_f32 v136, v40, v41
    v_cvt_pk_bf16_f32 v137, v42, v43
    ds_write_b64 v18, v[136:137] offset:0
    s_waitcnt vmcnt(0)
    v_mfma_f32_16x16x32_bf16 v[56:59], v[120:123], v[28:31], v[56:59]
    v_cvt_pk_bf16_f32 v138, v44, v45
    v_cvt_pk_bf16_f32 v139, v46, v47
    ds_write_b64 v19, v[138:139] offset:0
    v_mfma_f32_16x16x32_bf16 v[60:63], v[124:127], v[28:31], v[60:63]
    v_cvt_pk_bf16_f32 v140, v48, v49
    v_cvt_pk_bf16_f32 v141, v50, v51
    ds_write_b64 v20, v[140:141] offset:0
    v_mfma_f32_16x16x32_bf16 v[64:67], v[128:131], v[28:31], v[64:67]
    v_cvt_pk_bf16_f32 v142, v52, v53
    v_cvt_pk_bf16_f32 v143, v54, v55
    ds_write_b64 v21, v[142:143] offset:0
    v_mfma_f32_16x16x32_bf16 v[68:71], v[132:135], v[28:31], v[68:71]
    ds_read_b128 v[152:155], v17 offset:0
    ds_read_b128 v[156:159], v17 offset:1024
    s_nop 1
    v_cvt_pk_bf16_f32 v144, v56, v57
    v_cvt_pk_bf16_f32 v145, v58, v59
    ds_write_b64 v18, v[144:145] offset:2048
    v_cvt_pk_bf16_f32 v146, v60, v61
    v_cvt_pk_bf16_f32 v147, v62, v63
    ds_write_b64 v19, v[146:147] offset:2048
    s_waitcnt lgkmcnt(3)
    buffer_store_dwordx4 v[152:155], v7, s[20:23], s68 offen sc1
    s_add_u32 s68, s68, 0x4000
    s_waitcnt lgkmcnt(2)
    buffer_store_dwordx4 v[156:159], v7, s[20:23], s68 offen sc1
    s_add_u32 s68, s68, 0x4000
    v_cvt_pk_bf16_f32 v148, v64, v65
    v_cvt_pk_bf16_f32 v149, v66, v67
    ds_write_b64 v20, v[148:149] offset:2048
    v_cvt_pk_bf16_f32 v150, v68, v69
    v_cvt_pk_bf16_f32 v151, v70, v71
    ds_write_b64 v21, v[150:151] offset:2048
    ds_read_b128 v[160:163], v17 offset:2048
    ds_read_b128 v[164:167], v17 offset:3072
    s_waitcnt lgkmcnt(1)
    buffer_store_dwordx4 v[160:163], v7, s[20:23], s68 offen sc1
    s_add_u32 s68, s68, 0x4000
    s_waitcnt lgkmcnt(0)
    buffer_store_dwordx4 v[164:167], v7, s[20:23], s68 offen sc1
L_end:
    s_endpgm
    s_endpgm
L_c_15:
    s_cmp_eq_u32 s59, 0
    s_cbranch_scc1 L_A_nh
    s_waitcnt vmcnt(0)
    v_cmp_ne_u64 vcc, s[48:49], v[8:9]
    s_and_b32 s50, vcc_lo, 12
    s_cbranch_scc0 L_h_17
    s_mov_b32 s58, 0
    s_mov_b64 exec, 12
L_vp_18:
    buffer_load_dwordx2 v[8:9], v10, s[24:27], s65 offen sc1
    s_add_u32 s58, s58, 1
    s_cmp_gt_u32 s58, 400000
    s_waitcnt vmcnt(0)
    v_cmp_ne_u64 vcc, s[48:49], v[8:9]
    s_cbranch_scc1 L_vp_18d
    s_cbranch_vccnz L_vp_18
L_vp_18d:
    s_mov_b64 exec, -1
L_h_17:
    s_sub_u32 s50, s1, 12288
    s_sub_u32 s51, s1, 7168
    v_and_b32 v8, 0x2ff, v12
    buffer_load_dwordx4 v[176:179], v12, s[24:27], s50 offen offset:0 sc1
    buffer_load_dwordx4 v[180:183], v12, s[24:27], s50 offen offset:1024 sc1
    s_mov_b64 exec, s[60:61]
    buffer_load_dwordx4 v[160:163], v8, s[24:27], s51 offen offset:0 sc1
    buffer_load_dwordx4 v[164:167], v8, s[24:27], s51 offen offset:256 sc1
    s_mov_b64 exec, -1
    s_branch L_A_nh
    s_branch L_c_15r
L_c_16:
    s_waitcnt vmcnt(0)
    s_branch L_c_16r
L_A_first:
    v_mfma_f32_32x32x16_bf16 v[120:135], v[152:155], v[32:35], 0
    v_mfma_f32_32x32x16_bf16 v[120:135], v[156:159], v[36:39], v[120:135]
    s_branch L_A_norm
L_A_firstr:
    s_branch L_A_firstr
L_B_slow0:
    s_mov_b32 s53, 0
    v_mov_b32 v32, v16
    v_mov_b32 v33, v17
    v_mov_b32 v34, v18
    v_mov_b32 v35, v19
    s_branch L_B_slow
L_B_slow1:
    s_mov_b32 s53, 1
    v_mov_b32 v32, v20
    v_mov_b32 v33, v21
    v_mov_b32 v34, v22
    v_mov_b32 v35, v23
    v_add_u32 v2, 0x400, v2
    v_add_u32 v0, 0x400, v0
    v_add_u32 v3, 0x100, v3
    v_add_u32 v7, 0x100, v7
L_B_slow:
    s_waitcnt vmcnt(0)
    s_mov_b32 s50, 0x3f803f80
    v_mov_b32 v144, s50
    v_mov_b32 v145, s50
    v_mov_b32 v146, s50
    v_mov_b32 v147, s50
    v_mov_b32 v148, s50
    v_mov_b32 v149, s50
    v_mov_b32 v150, s50
    v_mov_b32 v151, s50
    v_mov_b32 v8, 0xff800000
    ds_read_b128 v[136:139], v2 offset:57344
    s_waitcnt lgkmcnt(0)
    v_mfma_f32_32x32x16_bf16 v[72:87], v[136:139], v[32:35], v[40:55]
    s_nop 11
    v_max3_f32 v8, v8, v72, v73
    v_max3_f32 v8, v8, v74, v75
    v_max3_f32 v8, v8, v76, v77
    v_max3_f32 v8, v8, v78, v79
    v_max3_f32 v8, v8, v80, v81
    v_max3_f32 v8, v8, v82, v83
    v_max3_f32 v8, v8, v84, v85
    v_max3_f32 v8, v8, v86, v87
    s_cmp_gt_u32 1, s59
    s_cbranch_scc1 L_B_s0
    ds_read_b128 v[136:139], v2 offset:49152
    s_waitcnt lgkmcnt(0)
    v_mfma_f32_32x32x16_bf16 v[72:87], v[136:139], v[32:35], 0
    s_nop 11
    v_max3_f32 v8, v8, v72, v73
    v_max3_f32 v8, v8, v74, v75
    v_max3_f32 v8, v8, v76, v77
    v_max3_f32 v8, v8, v78, v79
    v_max3_f32 v8, v8, v80, v81
    v_max3_f32 v8, v8, v82, v83
    v_max3_f32 v8, v8, v84, v85
    v_max3_f32 v8, v8, v86, v87
    s_cmp_gt_u32 2, s59
    s_cbranch_scc1 L_B_s0
    ds_read_b128 v[136:139], v2 offset:40960
    s_waitcnt lgkmcnt(0)
    v_mfma_f32_32x32x16_bf16 v[72:87], v[136:139], v[32:35], 0
    s_nop 11
    v_max3_f32 v8, v8, v72, v73
    v_max3_f32 v8, v8, v74, v75
    v_max3_f32 v8, v8, v76, v77
    v_max3_f32 v8, v8, v78, v79
    v_max3_f32 v8, v8, v80, v81
    v_max3_f32 v8, v8, v82, v83
    v_max3_f32 v8, v8, v84, v85
    v_max3_f32 v8, v8, v86, v87
    s_cmp_gt_u32 3, s59
    s_cbranch_scc1 L_B_s0
    ds_read_b128 v[136:139], v2 offset:32768
    s_waitcnt lgkmcnt(0)
    v_mfma_f32_32x32x16_bf16 v[72:87], v[136:139], v[32:35], 0
    s_nop 11
    v_max3_f32 v8, v8, v72, v73
    v_max3_f32 v8, v8, v74, v75
    v_max3_f32 v8, v8, v76, v77
    v_max3_f32 v8, v8, v78, v79
    v_max3_f32 v8, v8, v80, v81
    v_max3_f32 v8, v8, v82, v83
    v_max3_f32 v8, v8, v84, v85
    v_max3_f32 v8, v8, v86, v87
    s_cmp_gt_u32 4, s59
    s_cbranch_scc1 L_B_s0
    ds_read_b128 v[136:139], v2 offset:24576
    s_waitcnt lgkmcnt(0)
    v_mfma_f32_32x32x16_bf16 v[72:87], v[136:139], v[32:35], 0
    s_nop 11
    v_max3_f32 v8, v8, v72, v73
    v_max3_f32 v8, v8, v74, v75
    v_max3_f32 v8, v8, v76, v77
    v_max3_f32 v8, v8, v78, v79
    v_max3_f32 v8, v8, v80, v81
    v_max3_f32 v8, v8, v82, v83
    v_max3_f32 v8, v8, v84, v85
    v_max3_f32 v8, v8, v86, v87
    s_cmp_gt_u32 5, s59
    s_cbranch_scc1 L_B_s0
    ds_read_b128 v[136:139], v2 offset:16384
    s_waitcnt lgkmcnt(0)
    v_mfma_f32_32x32x16_bf16 v[72:87], v[136:139], v[32:35], 0
    s_nop 11
    v_max3_f32 v8, v8, v72, v73
    v_max3_f32 v8, v8, v74, v75
    v_max3_f32 v8, v8, v76, v77
    v_max3_f32 v8, v8, v78, v79
    v_max3_f32 v8, v8, v80, v81
    v_max3_f32 v8, v8, v82, v83
    v_max3_f32 v8, v8, v84, v85
    v_max3_f32 v8, v8, v86, v87
    s_cmp_gt_u32 6, s59
    s_cbranch_scc1 L_B_s0
    ds_read_b128 v[136:139], v2 offset:8192
    s_waitcnt lgkmcnt(0)
    v_mfma_f32_32x32x16_bf16 v[72:87], v[136:139], v[32:35], 0
    s_nop 11
    v_max3_f32 v8, v8, v72, v73
    v_max3_f32 v8, v8, v74, v75
    v_max3_f32 v8, v8, v76, v77
    v_max3_f32 v8, v8, v78, v79
    v_max3_f32 v8, v8, v80, v81
    v_max3_f32 v8, v8, v82, v83
    v_max3_f32 v8, v8, v84, v85
    v_max3_f32 v8, v8, v86, v87
    s_cmp_gt_u32 7, s59
    s_cbranch_scc1 L_B_s0
    ds_read_b128 v[136:139], v2 offset:0
    s_waitcnt lgkmcnt(0)
    v_mfma_f32_32x32x16_bf16 v[72:87], v[136:139], v[32:35], 0
    s_nop 11
    v_max3_f32 v8, v8, v72, v73
    v_max3_f32 v8, v8, v74, v75
    v_max3_f32 v8, v8, v76, v77
    v_max3_f32 v8, v8, v78, v79
    v_max3_f32 v8, v8, v80, v81
    v_max3_f32 v8, v8, v82, v83
    v_max3_f32 v8, v8, v84, v85
    v_max3_f32 v8, v8, v86, v87
    s_cmp_gt_u32 8, s59
    s_cbranch_scc1 L_B_s0
    ds_read_b128 v[136:139], v0 offset:0
    s_waitcnt lgkmcnt(0)
    v_mfma_f32_32x32x16_bf16 v[72:87], v[136:139], v[32:35], v[56:71]
    s_nop 11
    v_max3_f32 v8, v8, v72, v73
    v_max3_f32 v8, v8, v74, v75
    v_max3_f32 v8, v8, v76, v77
    v_max3_f32 v8, v8, v78, v79
    v_max3_f32 v8, v8, v80, v81
    v_max3_f32 v8, v8, v82, v83
    v_max3_f32 v8, v8, v84, v85
    v_max3_f32 v8, v8, v86, v87
L_B_s0:
    v_mov_b32 v10, v8
    s_nop 1
    v_permlane32_swap_b32 v10, v8
    s_nop 1
    v_max_f32 v8, v8, v10
    ds_read_b128 v[136:139], v2 offset:57344
    s_mov_b64 exec, s[60:61]
    ds_read_b128 v[144:147], v3 offset:57344
    ds_read_b128 v[148:151], v3 offset:58368
    s_mov_b64 exec, -1
    s_waitcnt lgkmcnt(0)
    v_mfma_f32_32x32x16_bf16 v[72:87], v[136:139], v[32:35], v[40:55]
    s_nop 11
    v_sub_f32 v72, v72, v8
    v_sub_f32 v73, v73, v8
    v_sub_f32 v74, v74, v8
    v_sub_f32 v75, v75, v8
    v_sub_f32 v76, v76, v8
    v_sub_f32 v77, v77, v8
    v_sub_f32 v78, v78, v8
    v_sub_f32 v79, v79, v8
    v_sub_f32 v80, v80, v8
    v_sub_f32 v81, v81, v8
    v_sub_f32 v82, v82, v8
    v_sub_f32 v83, v83, v8
    v_sub_f32 v84, v84, v8
    v_sub_f32 v85, v85, v8
    v_sub_f32 v86, v86, v8
    v_sub_f32 v87, v87, v8
    v_exp_f32 v72, v72
    v_exp_f32 v73, v73
    v_exp_f32 v74, v74
    v_exp_f32 v75, v75
    v_exp_f32 v76, v76
    v_exp_f32 v77, v77
    v_exp_f32 v78, v78
    v_exp_f32 v79, v79
    v_exp_f32 v80, v80
    v_exp_f32 v81, v81
    v_exp_f32 v82, v82
    v_exp_f32 v83, v83
    v_exp_f32 v84, v84
    v_exp_f32 v85, v85
    v_exp_f32 v86, v86
    v_exp_f32 v87, v87
    v_cvt_pk_bf16_f32 v176, v72, v73
    v_cvt_pk_bf16_f32 v177, v74, v75
    v_cvt_pk_bf16_f32 v178, v76, v77
    v_cvt_pk_bf16_f32 v179, v78, v79
    v_cvt_pk_bf16_f32 v180, v80, v81
    v_cvt_pk_bf16_f32 v181, v82, v83
    v_cvt_pk_bf16_f32 v182, v84, v85
    v_cvt_pk_bf16_f32 v183, v86, v87
    s_nop 1
    v_mfma_f32_32x32x16_bf16 v[104:119], v[144:147], v[176:179], 0
    v_mfma_f32_32x32x16_bf16 v[104:119], v[148:151], v[180:183], v[104:119]
    s_nop 7
    s_cmp_gt_u32 1, s59
    s_cbranch_scc1 L_B_s1
    ds_read_b128 v[136:139], v2 offset:49152
    s_mov_b64 exec, s[60:61]
    ds_read_b128 v[144:147], v3 offset:49152
    ds_read_b128 v[148:151], v3 offset:50176
    s_mov_b64 exec, -1
    s_waitcnt lgkmcnt(0)
    v_mfma_f32_32x32x16_bf16 v[72:87], v[136:139], v[32:35], 0
    s_nop 11
    v_sub_f32 v72, v72, v8
    v_sub_f32 v73, v73, v8
    v_sub_f32 v74, v74, v8
    v_sub_f32 v75, v75, v8
    v_sub_f32 v76, v76, v8
    v_sub_f32 v77, v77, v8
    v_sub_f32 v78, v78, v8
    v_sub_f32 v79, v79, v8
    v_sub_f32 v80, v80, v8
    v_sub_f32 v81, v81, v8
    v_sub_f32 v82, v82, v8
    v_sub_f32 v83, v83, v8
    v_sub_f32 v84, v84, v8
    v_sub_f32 v85, v85, v8
    v_sub_f32 v86, v86, v8
    v_sub_f32 v87, v87, v8
    v_exp_f32 v72, v72
    v_exp_f32 v73, v73
    v_exp_f32 v74, v74
    v_exp_f32 v75, v75
    v_exp_f32 v76, v76
    v_exp_f32 v77, v77
    v_exp_f32 v78, v78
    v_exp_f32 v79, v79
    v_exp_f32 v80, v80
    v_exp_f32 v81, v81
    v_exp_f32 v82, v82
    v_exp_f32 v83, v83
    v_exp_f32 v84, v84
    v_exp_f32 v85, v85
    v_exp_f32 v86, v86
    v_exp_f32 v87, v87
    v_cvt_pk_bf16_f32 v176, v72, v73
    v_cvt_pk_bf16_f32 v177, v74, v75
    v_cvt_pk_bf16_f32 v178, v76, v77
    v_cvt_pk_bf16_f32 v179, v78, v79
    v_cvt_pk_bf16_f32 v180, v80, v81
    v_cvt_pk_bf16_f32 v181, v82, v83
    v_cvt_pk_bf16_f32 v182, v84, v85
    v_cvt_pk_bf16_f32 v183, v86, v87
    s_nop 1
    v_mfma_f32_32x32x16_bf16 v[104:119], v[144:147], v[176:179], v[104:119]
    v_mfma_f32_32x32x16_bf16 v[104:119], v[148:151], v[180:183], v[104:119]
    s_nop 7
    s_cmp_gt_u32 2, s59
    s_cbranch_scc1 L_B_s1
    ds_read_b128 v[136:139], v2 offset:40960
    s_mov_b64 exec, s[60:61]
    ds_read_b128 v[144:147], v3 offset:40960
    ds_read_b128 v[148:151], v3 offset:41984
    s_mov_b64 exec, -1
    s_waitcnt lgkmcnt(0)
    v_mfma_f32_32x32x16_bf16 v[72:87], v[136:139], v[32:35], 0
    s_nop 11
    v_sub_f32 v72, v72, v8
    v_sub_f32 v73, v73, v8
    v_sub_f32 v74, v74, v8
    v_sub_f32 v75, v75, v8
    v_sub_f32 v76, v76, v8
    v_sub_f32 v77, v77, v8
    v_sub_f32 v78, v78, v8
    v_sub_f32 v79, v79, v8
    v_sub_f32 v80, v80, v8
    v_sub_f32 v81, v81, v8
    v_sub_f32 v82, v82, v8
    v_sub_f32 v83, v83, v8
    v_sub_f32 v84, v84, v8
    v_sub_f32 v85, v85, v8
    v_sub_f32 v86, v86, v8
    v_sub_f32 v87, v87, v8
    v_exp_f32 v72, v72
    v_exp_f32 v73, v73
    v_exp_f32 v74, v74
    v_exp_f32 v75, v75
    v_exp_f32 v76, v76
    v_exp_f32 v77, v77
    v_exp_f32 v78, v78
    v_exp_f32 v79, v79
    v_exp_f32 v80, v80
    v_exp_f32 v81, v81
    v_exp_f32 v82, v82
    v_exp_f32 v83, v83
    v_exp_f32 v84, v84
    v_exp_f32 v85, v85
    v_exp_f32 v86, v86
    v_exp_f32 v87, v87
    v_cvt_pk_bf16_f32 v176, v72, v73
    v_cvt_pk_bf16_f32 v177, v74, v75
    v_cvt_pk_bf16_f32 v178, v76, v77
    v_cvt_pk_bf16_f32 v179, v78, v79
    v_cvt_pk_bf16_f32 v180, v80, v81
    v_cvt_pk_bf16_f32 v181, v82, v83
    v_cvt_pk_bf16_f32 v182, v84, v85
    v_cvt_pk_bf16_f32 v183, v86, v87
    s_nop 1
    v_mfma_f32_32x32x16_bf16 v[104:119], v[144:147], v[176:179], v[104:119]
    v_mfma_f32_32x32x16_bf16 v[104:119], v[148:151], v[180:183], v[104:119]
    s_nop 7
    s_cmp_gt_u32 3, s59
    s_cbranch_scc1 L_B_s1
    ds_read_b128 v[136:139], v2 offset:32768
    s_mov_b64 exec, s[60:61]
    ds_read_b128 v[144:147], v3 offset:32768
    ds_read_b128 v[148:151], v3 offset:33792
    s_mov_b64 exec, -1
    s_waitcnt lgkmcnt(0)
    v_mfma_f32_32x32x16_bf16 v[72:87], v[136:139], v[32:35], 0
    s_nop 11
    v_sub_f32 v72, v72, v8
    v_sub_f32 v73, v73, v8
    v_sub_f32 v74, v74, v8
    v_sub_f32 v75, v75, v8
    v_sub_f32 v76, v76, v8
    v_sub_f32 v77, v77, v8
    v_sub_f32 v78, v78, v8
    v_sub_f32 v79, v79, v8
    v_sub_f32 v80, v80, v8
    v_sub_f32 v81, v81, v8
    v_sub_f32 v82, v82, v8
    v_sub_f32 v83, v83, v8
    v_sub_f32 v84, v84, v8
    v_sub_f32 v85, v85, v8
    v_sub_f32 v86, v86, v8
    v_sub_f32 v87, v87, v8
    v_exp_f32 v72, v72
    v_exp_f32 v73, v73
    v_exp_f32 v74, v74
    v_exp_f32 v75, v75
    v_exp_f32 v76, v76
    v_exp_f32 v77, v77
    v_exp_f32 v78, v78
    v_exp_f32 v79, v79
    v_exp_f32 v80, v80
    v_exp_f32 v81, v81
    v_exp_f32 v82, v82
    v_exp_f32 v83, v83
    v_exp_f32 v84, v84
    v_exp_f32 v85, v85
    v_exp_f32 v86, v86
    v_exp_f32 v87, v87
    v_cvt_pk_bf16_f32 v176, v72, v73
    v_cvt_pk_bf16_f32 v177, v74, v75
    v_cvt_pk_bf16_f32 v178, v76, v77
    v_cvt_pk_bf16_f32 v179, v78, v79
    v_cvt_pk_bf16_f32 v180, v80, v81
    v_cvt_pk_bf16_f32 v181, v82, v83
    v_cvt_pk_bf16_f32 v182, v84, v85
    v_cvt_pk_bf16_f32 v183, v86, v87
    s_nop 1
    v_mfma_f32_32x32x16_bf16 v[104:119], v[144:147], v[176:179], v[104:119]
    v_mfma_f32_32x32x16_bf16 v[104:119], v[148:151], v[180:183], v[104:119]
    s_nop 7
    s_cmp_gt_u32 4, s59
    s_cbranch_scc1 L_B_s1
    ds_read_b128 v[136:139], v2 offset:24576
    s_mov_b64 exec, s[60:61]
    ds_read_b128 v[144:147], v3 offset:24576
    ds_read_b128 v[148:151], v3 offset:25600
    s_mov_b64 exec, -1
    s_waitcnt lgkmcnt(0)
    v_mfma_f32_32x32x16_bf16 v[72:87], v[136:139], v[32:35], 0
    s_nop 11
    v_sub_f32 v72, v72, v8
    v_sub_f32 v73, v73, v8
    v_sub_f32 v74, v74, v8
    v_sub_f32 v75, v75, v8
    v_sub_f32 v76, v76, v8
    v_sub_f32 v77, v77, v8
    v_sub_f32 v78, v78, v8
    v_sub_f32 v79, v79, v8
    v_sub_f32 v80, v80, v8
    v_sub_f32 v81, v81, v8
    v_sub_f32 v82, v82, v8
    v_sub_f32 v83, v83, v8
    v_sub_f32 v84, v84, v8
    v_sub_f32 v85, v85, v8
    v_sub_f32 v86, v86, v8
    v_sub_f32 v87, v87, v8
    v_exp_f32 v72, v72
    v_exp_f32 v73, v73
    v_exp_f32 v74, v74
    v_exp_f32 v75, v75
    v_exp_f32 v76, v76
    v_exp_f32 v77, v77
    v_exp_f32 v78, v78
    v_exp_f32 v79, v79
    v_exp_f32 v80, v80
    v_exp_f32 v81, v81
    v_exp_f32 v82, v82
    v_exp_f32 v83, v83
    v_exp_f32 v84, v84
    v_exp_f32 v85, v85
    v_exp_f32 v86, v86
    v_exp_f32 v87, v87
    v_cvt_pk_bf16_f32 v176, v72, v73
    v_cvt_pk_bf16_f32 v177, v74, v75
    v_cvt_pk_bf16_f32 v178, v76, v77
    v_cvt_pk_bf16_f32 v179, v78, v79
    v_cvt_pk_bf16_f32 v180, v80, v81
    v_cvt_pk_bf16_f32 v181, v82, v83
    v_cvt_pk_bf16_f32 v182, v84, v85
    v_cvt_pk_bf16_f32 v183, v86, v87
    s_nop 1
    v_mfma_f32_32x32x16_bf16 v[104:119], v[144:147], v[176:179], v[104:119]
    v_mfma_f32_32x32x16_bf16 v[104:119], v[148:151], v[180:183], v[104:119]
    s_nop 7
    s_cmp_gt_u32 5, s59
    s_cbranch_scc1 L_B_s1
    ds_read_b128 v[136:139], v2 offset:16384
    s_mov_b64 exec, s[60:61]
    ds_read_b128 v[144:147], v3 offset:16384
    ds_read_b128 v[148:151], v3 offset:17408
    s_mov_b64 exec, -1
    s_waitcnt lgkmcnt(0)
    v_mfma_f32_32x32x16_bf16 v[72:87], v[136:139], v[32:35], 0
    s_nop 11
    v_sub_f32 v72, v72, v8
    v_sub_f32 v73, v73, v8
    v_sub_f32 v74, v74, v8
    v_sub_f32 v75, v75, v8
    v_sub_f32 v76, v76, v8
    v_sub_f32 v77, v77, v8
    v_sub_f32 v78, v78, v8
    v_sub_f32 v79, v79, v8
    v_sub_f32 v80, v80, v8
    v_sub_f32 v81, v81, v8
    v_sub_f32 v82, v82, v8
    v_sub_f32 v83, v83, v8
    v_sub_f32 v84, v84, v8
    v_sub_f32 v85, v85, v8
    v_sub_f32 v86, v86, v8
    v_sub_f32 v87, v87, v8
    v_exp_f32 v72, v72
    v_exp_f32 v73, v73
    v_exp_f32 v74, v74
    v_exp_f32 v75, v75
    v_exp_f32 v76, v76
    v_exp_f32 v77, v77
    v_exp_f32 v78, v78
    v_exp_f32 v79, v79
    v_exp_f32 v80, v80
    v_exp_f32 v81, v81
    v_exp_f32 v82, v82
    v_exp_f32 v83, v83
    v_exp_f32 v84, v84
    v_exp_f32 v85, v85
    v_exp_f32 v86, v86
    v_exp_f32 v87, v87
    v_cvt_pk_bf16_f32 v176, v72, v73
    v_cvt_pk_bf16_f32 v177, v74, v75
    v_cvt_pk_bf16_f32 v178, v76, v77
    v_cvt_pk_bf16_f32 v179, v78, v79
    v_cvt_pk_bf16_f32 v180, v80, v81
    v_cvt_pk_bf16_f32 v181, v82, v83
    v_cvt_pk_bf16_f32 v182, v84, v85
    v_cvt_pk_bf16_f32 v183, v86, v87
    s_nop 1
    v_mfma_f32_32x32x16_bf16 v[104:119], v[144:147], v[176:179], v[104:119]
    v_mfma_f32_32x32x16_bf16 v[104:119], v[148:151], v[180:183], v[104:119]
    s_nop 7
    s_cmp_gt_u32 6, s59
    s_cbranch_scc1 L_B_s1
    ds_read_b128 v[136:139], v2 offset:8192
    s_mov_b64 exec, s[60:61]
    ds_read_b128 v[144:147], v3 offset:8192
    ds_read_b128 v[148:151], v3 offset:9216
    s_mov_b64 exec, -1
    s_waitcnt lgkmcnt(0)
    v_mfma_f32_32x32x16_bf16 v[72:87], v[136:139], v[32:35], 0
    s_nop 11
    v_sub_f32 v72, v72, v8
    v_sub_f32 v73, v73, v8
    v_sub_f32 v74, v74, v8
    v_sub_f32 v75, v75, v8
    v_sub_f32 v76, v76, v8
    v_sub_f32 v77, v77, v8
    v_sub_f32 v78, v78, v8
    v_sub_f32 v79, v79, v8
    v_sub_f32 v80, v80, v8
    v_sub_f32 v81, v81, v8
    v_sub_f32 v82, v82, v8
    v_sub_f32 v83, v83, v8
    v_sub_f32 v84, v84, v8
    v_sub_f32 v85, v85, v8
    v_sub_f32 v86, v86, v8
    v_sub_f32 v87, v87, v8
    v_exp_f32 v72, v72
    v_exp_f32 v73, v73
    v_exp_f32 v74, v74
    v_exp_f32 v75, v75
    v_exp_f32 v76, v76
    v_exp_f32 v77, v77
    v_exp_f32 v78, v78
    v_exp_f32 v79, v79
    v_exp_f32 v80, v80
    v_exp_f32 v81, v81
    v_exp_f32 v82, v82
    v_exp_f32 v83, v83
    v_exp_f32 v84, v84
    v_exp_f32 v85, v85
    v_exp_f32 v86, v86
    v_exp_f32 v87, v87
    v_cvt_pk_bf16_f32 v176, v72, v73
    v_cvt_pk_bf16_f32 v177, v74, v75
    v_cvt_pk_bf16_f32 v178, v76, v77
    v_cvt_pk_bf16_f32 v179, v78, v79
    v_cvt_pk_bf16_f32 v180, v80, v81
    v_cvt_pk_bf16_f32 v181, v82, v83
    v_cvt_pk_bf16_f32 v182, v84, v85
    v_cvt_pk_bf16_f32 v183, v86, v87
    s_nop 1
    v_mfma_f32_32x32x16_bf16 v[104:119], v[144:147], v[176:179], v[104:119]
    v_mfma_f32_32x32x16_bf16 v[104:119], v[148:151], v[180:183], v[104:119]
    s_nop 7
    s_cmp_gt_u32 7, s59
    s_cbranch_scc1 L_B_s1
    ds_read_b128 v[136:139], v2 offset:0
    s_mov_b64 exec, s[60:61]
    ds_read_b128 v[144:147], v3 offset:0
    ds_read_b128 v[148:151], v3 offset:1024
    s_mov_b64 exec, -1
    s_waitcnt lgkmcnt(0)
    v_mfma_f32_32x32x16_bf16 v[72:87], v[136:139], v[32:35], 0
    s_nop 11
    v_sub_f32 v72, v72, v8
    v_sub_f32 v73, v73, v8
    v_sub_f32 v74, v74, v8
    v_sub_f32 v75, v75, v8
    v_sub_f32 v76, v76, v8
    v_sub_f32 v77, v77, v8
    v_sub_f32 v78, v78, v8
    v_sub_f32 v79, v79, v8
    v_sub_f32 v80, v80, v8
    v_sub_f32 v81, v81, v8
    v_sub_f32 v82, v82, v8
    v_sub_f32 v83, v83, v8
    v_sub_f32 v84, v84, v8
    v_sub_f32 v85, v85, v8
    v_sub_f32 v86, v86, v8
    v_sub_f32 v87, v87, v8
    v_exp_f32 v72, v72
    v_exp_f32 v73, v73
    v_exp_f32 v74, v74
    v_exp_f32 v75, v75
    v_exp_f32 v76, v76
    v_exp_f32 v77, v77
    v_exp_f32 v78, v78
    v_exp_f32 v79, v79
    v_exp_f32 v80, v80
    v_exp_f32 v81, v81
    v_exp_f32 v82, v82
    v_exp_f32 v83, v83
    v_exp_f32 v84, v84
    v_exp_f32 v85, v85
    v_exp_f32 v86, v86
    v_exp_f32 v87, v87
    v_cvt_pk_bf16_f32 v176, v72, v73
    v_cvt_pk_bf16_f32 v177, v74, v75
    v_cvt_pk_bf16_f32 v178, v76, v77
    v_cvt_pk_bf16_f32 v179, v78, v79
    v_cvt_pk_bf16_f32 v180, v80, v81
    v_cvt_pk_bf16_f32 v181, v82, v83
    v_cvt_pk_bf16_f32 v182, v84, v85
    v_cvt_pk_bf16_f32 v183, v86, v87
    s_nop 1
    v_mfma_f32_32x32x16_bf16 v[104:119], v[144:147], v[176:179], v[104:119]
    v_mfma_f32_32x32x16_bf16 v[104:119], v[148:151], v[180:183], v[104:119]
    s_nop 7
    s_cmp_gt_u32 8, s59
    s_cbranch_scc1 L_B_s1
    ds_read_b128 v[136:139], v0 offset:0
    s_mov_b64 exec, s[60:61]
    ds_read_b128 v[144:147], v7 offset:0
    ds_read_b128 v[148:151], v7 offset:1024
    s_mov_b64 exec, -1
    s_waitcnt lgkmcnt(0)
    v_mfma_f32_32x32x16_bf16 v[72:87], v[136:139], v[32:35], v[56:71]
    s_nop 11
    v_sub_f32 v72, v72, v8
    v_sub_f32 v73, v73, v8
    v_sub_f32 v74, v74, v8
    v_sub_f32 v75, v75, v8
    v_sub_f32 v76, v76, v8
    v_sub_f32 v77, v77, v8
    v_sub_f32 v78, v78, v8
    v_sub_f32 v79, v79, v8
    v_sub_f32 v80, v80, v8
    v_sub_f32 v81, v81, v8
    v_sub_f32 v82, v82, v8
    v_sub_f32 v83, v83, v8
    v_sub_f32 v84, v84, v8
    v_sub_f32 v85, v85, v8
    v_sub_f32 v86, v86, v8
    v_sub_f32 v87, v87, v8
    v_exp_f32 v72, v72
    v_exp_f32 v73, v73
    v_exp_f32 v74, v74
    v_exp_f32 v75, v75
    v_exp_f32 v76, v76
    v_exp_f32 v77, v77
    v_exp_f32 v78, v78
    v_exp_f32 v79, v79
    v_exp_f32 v80, v80
    v_exp_f32 v81, v81
    v_exp_f32 v82, v82
    v_exp_f32 v83, v83
    v_exp_f32 v84, v84
    v_exp_f32 v85, v85
    v_exp_f32 v86, v86
    v_exp_f32 v87, v87
    v_cvt_pk_bf16_f32 v176, v72, v73
    v_cvt_pk_bf16_f32 v177, v74, v75
    v_cvt_pk_bf16_f32 v178, v76, v77
    v_cvt_pk_bf16_f32 v179, v78, v79
    v_cvt_pk_bf16_f32 v180, v80, v81
    v_cvt_pk_bf16_f32 v181, v82, v83
    v_cvt_pk_bf16_f32 v182, v84, v85
    v_cvt_pk_bf16_f32 v183, v86, v87
    s_nop 1
    v_mfma_f32_32x32x16_bf16 v[104:119], v[144:147], v[176:179], v[104:119]
    v_mfma_f32_32x32x16_bf16 v[104:119], v[148:151], v[180:183], v[104:119]
    s_nop 7
L_B_s1:
    s_nop 11
    v_rcp_f32 v114, v112
    v_pk_add_f32 v[116:117], v[104:105], v[106:107]
    v_pk_add_f32 v[118:119], v[108:109], v[110:111]
    v_pk_mul_f32 v[104:105], v[104:105], v[114:115] op_sel_hi:[1,0]
    v_pk_mul_f32 v[106:107], v[106:107], v[114:115] op_sel_hi:[1,0]
    v_pk_mul_f32 v[108:109], v[108:109], v[114:115] op_sel_hi:[1,0]
    v_pk_mul_f32 v[110:111], v[110:111], v[114:115] op_sel_hi:[1,0]
    v_pk_add_f32 v[116:117], v[116:117], v[118:119]
    v_cvt_pk_bf16_f32 v28, v104, v105
    v_cvt_pk_bf16_f32 v29, v106, v107
    v_cvt_pk_bf16_f32 v30, v108, v109
    v_cvt_pk_bf16_f32 v31, v110, v111
    v_add_f32 v116, v116, v117
    v_fma_f32 v112, v116, 0, v112
    s_cmp_eq_u32 s53, 0
    s_cbranch_scc1 L_B_fin0
    v_subrev_u32 v2, 0x400, v2
    v_subrev_u32 v0, 0x400, v0
    v_subrev_u32 v3, 0x100, v3
    v_subrev_u32 v7, 0x100, v7
    s_branch L_B_ok1
L_B_fin0:
    buffer_store_dwordx4 v[28:31], v12, s[24:27], s68 offen sc1
    s_waitcnt vmcnt(0)
    s_mov_b64 exec, 0xffff
    buffer_store_dwordx2 v[14:15], v13, s[24:27], s69 offen sc1
    s_mov_b64 exec, -1
    s_branch L_B_ok0
L_A_slow:
    s_waitcnt vmcnt(0)
    v_mov_b32 v8, 0xff800000
    v_mfma_f32_32x32x16_bf16 v[72:87], v[140:143], v[16:19], v[40:55]
    s_nop 11
    v_max3_f32 v8, v8, v72, v73
    v_max3_f32 v8, v8, v74, v75
    v_max3_f32 v8, v8, v76, v77
    v_max3_f32 v8, v8, v78, v79
    v_max3_f32 v8, v8, v80, v81
    v_max3_f32 v8, v8, v82, v83
    v_max3_f32 v8, v8, v84, v85
    v_max3_f32 v8, v8, v86, v87
    s_cmp_eq_u32 s59, 0
    s_cbranch_scc1 L_A_m0
    v_mfma_f32_32x32x16_bf16 v[72:87], v[176:179], v[16:19], v[56:71]
    s_nop 11
    v_max3_f32 v8, v8, v80, v81
    v_max3_f32 v8, v8, v82, v83
    v_max3_f32 v8, v8, v84, v85
    v_max3_f32 v8, v8, v86, v87
L_A_m0:
    v_mov_b32 v10, v8
    s_nop 1
    v_permlane32_swap_b32 v10, v8
    s_nop 1
    v_max_f32 v8, v8, v10
    v_mov_b32 v9, 0xff800000
    v_mfma_f32_32x32x16_bf16 v[72:87], v[136:139], v[20:23], v[40:55]
    s_nop 11
    v_max3_f32 v9, v9, v72, v73
    v_max3_f32 v9, v9, v74, v75
    v_max3_f32 v9, v9, v76, v77
    v_max3_f32 v9, v9, v78, v79
    v_max3_f32 v9, v9, v80, v81
    v_max3_f32 v9, v9, v82, v83
    v_max3_f32 v9, v9, v84, v85
    v_max3_f32 v9, v9, v86, v87
    s_cmp_eq_u32 s59, 0
    s_cbranch_scc1 L_A_m1
    v_mfma_f32_32x32x16_bf16 v[72:87], v[180:183], v[20:23], v[56:71]
    s_nop 11
    v_max3_f32 v9, v9, v80, v81
    v_max3_f32 v9, v9, v82, v83
    v_max3_f32 v9, v9, v84, v85
    v_max3_f32 v9, v9, v86, v87
L_A_m1:
    v_mov_b32 v10, v9
    s_nop 1
    v_permlane32_swap_b32 v10, v9
    s_nop 1
    v_max_f32 v9, v9, v10
    v_mfma_f32_32x32x16_bf16 v[72:87], v[140:143], v[16:19], v[40:55]
    v_mfma_f32_32x32x16_bf16 v[88:103], v[136:139], v[20:23], v[40:55]
    s_nop 10
    v_sub_f32 v72, v72, v8
    v_exp_f32 v72, v72
    v_sub_f32 v73, v73, v8
    v_exp_f32 v73, v73
    v_sub_f32 v74, v74, v8
    v_exp_f32 v74, v74
    v_sub_f32 v75, v75, v8
    v_exp_f32 v75, v75
    v_sub_f32 v76, v76, v8
    v_exp_f32 v76, v76
    v_sub_f32 v77, v77, v8
    v_exp_f32 v77, v77
    v_sub_f32 v78, v78, v8
    v_exp_f32 v78, v78
    v_sub_f32 v79, v79, v8
    v_exp_f32 v79, v79
    v_sub_f32 v80, v80, v8
    v_exp_f32 v80, v80
    v_sub_f32 v81, v81, v8
    v_exp_f32 v81, v81
    v_sub_f32 v82, v82, v8
    v_exp_f32 v82, v82
    v_sub_f32 v83, v83, v8
    v_exp_f32 v83, v83
    v_sub_f32 v84, v84, v8
    v_exp_f32 v84, v84
    v_sub_f32 v85, v85, v8
    v_exp_f32 v85, v85
    v_sub_f32 v86, v86, v8
    v_exp_f32 v86, v86
    v_sub_f32 v87, v87, v8
    v_exp_f32 v87, v87
    v_cvt_pk_bf16_f32 v24, v72, v73
    v_cvt_pk_bf16_f32 v25, v74, v75
    v_cvt_pk_bf16_f32 v26, v76, v77
    v_cvt_pk_bf16_f32 v27, v78, v79
    v_cvt_pk_bf16_f32 v28, v80, v81
    v_cvt_pk_bf16_f32 v29, v82, v83
    v_cvt_pk_bf16_f32 v30, v84, v85
    v_cvt_pk_bf16_f32 v31, v86, v87
    s_nop 1
    v_mfma_f32_32x32x16_bf16 v[104:119], v[144:147], v[24:27], 0
    v_mfma_f32_32x32x16_bf16 v[104:119], v[148:151], v[28:31], v[104:119]
    v_sub_f32 v88, v88, v9
    v_exp_f32 v88, v88
    v_sub_f32 v89, v89, v9
    v_exp_f32 v89, v89
    v_sub_f32 v90, v90, v9
    v_exp_f32 v90, v90
    v_sub_f32 v91, v91, v9
    v_exp_f32 v91, v91
    v_sub_f32 v92, v92, v9
    v_exp_f32 v92, v92
    v_sub_f32 v93, v93, v9
    v_exp_f32 v93, v93
    v_sub_f32 v94, v94, v9
    v_exp_f32 v94, v94
    v_sub_f32 v95, v95, v9
    v_exp_f32 v95, v95
    v_sub_f32 v96, v96, v9
    v_exp_f32 v96, v96
    v_sub_f32 v97, v97, v9
    v_exp_f32 v97, v97
    v_sub_f32 v98, v98, v9
    v_exp_f32 v98, v98
    v_sub_f32 v99, v99, v9
    v_exp_f32 v99, v99
    v_sub_f32 v100, v100, v9
    v_exp_f32 v100, v100
    v_sub_f32 v101, v101, v9
    v_exp_f32 v101, v101
    v_sub_f32 v102, v102, v9
    v_exp_f32 v102, v102
    v_sub_f32 v103, v103, v9
    v_exp_f32 v103, v103
    v_cvt_pk_bf16_f32 v32, v88, v89
    v_cvt_pk_bf16_f32 v33, v90, v91
    v_cvt_pk_bf16_f32 v34, v92, v93
    v_cvt_pk_bf16_f32 v35, v94, v95
    v_cvt_pk_bf16_f32 v36, v96, v97
    v_cvt_pk_bf16_f32 v37, v98, v99
    v_cvt_pk_bf16_f32 v38, v100, v101
    v_cvt_pk_bf16_f32 v39, v102, v103
    s_nop 1
    v_mfma_f32_32x32x16_bf16 v[120:135], v[152:155], v[32:35], 0
    v_mfma_f32_32x32x16_bf16 v[120:135], v[156:159], v[36:39], v[120:135]
    s_waitcnt vmcnt(0)
    s_cmp_eq_u32 s59, 0
    s_cbranch_scc1 L_A_s2
    v_mfma_f32_32x32x16_bf16 v[72:87], v[176:179], v[16:19], v[56:71]
    v_mfma_f32_32x32x16_bf16 v[88:103], v[180:183], v[20:23], v[56:71]
    s_nop 10
    v_sub_f32 v80, v80, v8
    v_exp_f32 v80, v80
    v_sub_f32 v81, v81, v8
    v_exp_f32 v81, v81
    v_sub_f32 v82, v82, v8
    v_exp_f32 v82, v82
    v_sub_f32 v83, v83, v8
    v_exp_f32 v83, v83
    v_sub_f32 v84, v84, v8
    v_exp_f32 v84, v84
    v_sub_f32 v85, v85, v8
    v_exp_f32 v85, v85
    v_sub_f32 v86, v86, v8
    v_exp_f32 v86, v86
    v_sub_f32 v87, v87, v8
    v_exp_f32 v87, v87
    v_cvt_pk_bf16_f32 v28, v80, v81
    v_cvt_pk_bf16_f32 v29, v82, v83
    v_cvt_pk_bf16_f32 v30, v84, v85
    v_cvt_pk_bf16_f32 v31, v86, v87
    s_nop 1
    v_mfma_f32_32x32x16_bf16 v[104:119], v[160:163], v[28:31], v[104:119]
    v_sub_f32 v96, v96, v9
    v_exp_f32 v96, v96
    v_sub_f32 v97, v97, v9
    v_exp_f32 v97, v97
    v_sub_f32 v98, v98, v9
    v_exp_f32 v98, v98
    v_sub_f32 v99, v99, v9
    v_exp_f32 v99, v99
    v_sub_f32 v100, v100, v9
    v_exp_f32 v100, v100
    v_sub_f32 v101, v101, v9
    v_exp_f32 v101, v101
    v_sub_f32 v102, v102, v9
    v_exp_f32 v102, v102
    v_sub_f32 v103, v103, v9
    v_exp_f32 v103, v103
    v_cvt_pk_bf16_f32 v36, v96, v97
    v_cvt_pk_bf16_f32 v37, v98, v99
    v_cvt_pk_bf16_f32 v38, v100, v101
    v_cvt_pk_bf16_f32 v39, v102, v103
    s_nop 1
    v_mfma_f32_32x32x16_bf16 v[120:135], v[164:167], v[36:39], v[120:135]
L_A_s2:
    s_nop 11
    v_rcp_f32 v114, v112
    v_pk_add_f32 v[116:117], v[104:105], v[106:107]
    v_pk_add_f32 v[118:119], v[108:109], v[110:111]
    v_pk_mul_f32 v[104:105], v[104:105], v[114:115] op_sel_hi:[1,0]
    v_pk_mul_f32 v[106:107], v[106:107], v[114:115] op_sel_hi:[1,0]
    v_pk_mul_f32 v[108:109], v[108:109], v[114:115] op_sel_hi:[1,0]
    v_pk_mul_f32 v[110:111], v[110:111], v[114:115] op_sel_hi:[1,0]
    v_pk_add_f32 v[116:117], v[116:117], v[118:119]
    v_cvt_pk_bf16_f32 v24, v104, v105
    v_cvt_pk_bf16_f32 v25, v106, v107
    v_cvt_pk_bf16_f32 v26, v108, v109
    v_cvt_pk_bf16_f32 v27, v110, v111
    v_add_f32 v116, v116, v117
    v_fma_f32 v112, v116, 0, v112
    v_rcp_f32 v130, v128
    v_pk_add_f32 v[132:133], v[120:121], v[122:123]
    v_pk_add_f32 v[134:135], v[124:125], v[126:127]
    v_pk_mul_f32 v[120:121], v[120:121], v[130:131] op_sel_hi:[1,0]
    v_pk_mul_f32 v[122:123], v[122:123], v[130:131] op_sel_hi:[1,0]
    v_pk_mul_f32 v[124:125], v[124:125], v[130:131] op_sel_hi:[1,0]
    v_pk_mul_f32 v[126:127], v[126:127], v[130:131] op_sel_hi:[1,0]
    v_pk_add_f32 v[132:133], v[132:133], v[134:135]
    v_cvt_pk_bf16_f32 v28, v120, v121
    v_cvt_pk_bf16_f32 v29, v122, v123
    v_cvt_pk_bf16_f32 v30, v124, v125
    v_cvt_pk_bf16_f32 v31, v126, v127
    v_add_f32 v132, v132, v133
    v_fma_f32 v128, v132, 0, v128
    s_branch L_A_ok
    s_endpgm
.section .rodata,"a"
.p2align 6
.amdhsa_kernel concat_heads__sliding_local_dilated__sliding_block__prompt_kernel
  .amdhsa_next_free_vgpr 256
  .amdhsa_next_free_sgpr 72
  .amdhsa_accum_offset 256
  .amdhsa_group_segment_fixed_size 0
  .amdhsa_kernarg_size 72
  .amdhsa_user_sgpr_count 2
  .amdhsa_user_sgpr_kernarg_segment_ptr 1
  .amdhsa_system_sgpr_workgroup_id_x 1
.end_amdhsa_kernel
```
